```python
import torch

def _softmax(x, axis=-1):
    return torch.softmax(x, dim=axis)
def _gelu(x):
    return torch.nn.functional.gelu(x, approximate="tanh")
def _silu(x):
    return torch.nn.functional.silu(x)
def _sigmoid(x):
    return torch.sigmoid(x)
def _layernorm(x, axis=-1, eps=1e-5):
    m = x.mean(dim=axis, keepdim=True)
    v = x.var(dim=axis, keepdim=True, unbiased=False)
    return (x - m) / torch.sqrt(v + eps)
def _scatter_add(tgt, idx, src, axis=0):
    return tgt.clone().index_add_(axis, idx, src)
def _segment_sum(src, seg, n):
    out = torch.zeros((n,) + src.shape[1:], dtype=src.dtype)
    return out.index_add_(0, seg, src)
def _pad(x, pw):
    flat = tuple(v for pair in reversed(pw) for v in pair)
    return torch.nn.functional.pad(x, flat)

kernel_name = 'interleave_layers__mha_block__ssm_conv_h3__prompt'

def setup_inputs():

    _w = (lambda a: (lambda t: t.to(torch.bfloat16) if t.is_floating_point() else t)(torch.as_tensor(a)))
    def _A_setup():
        B, S, D, H = 1, 2048, 512, 32
        return {
            "x": _w((lambda *s: torch.randn(*s, dtype=torch.bfloat16) * 0.05)(B, S, D)),
            "wqkv": _w((lambda *s: torch.randn(*s, dtype=torch.bfloat16) * 0.05)(D, 3 * D)),
            "wo": _w((lambda *s: torch.randn(*s, dtype=torch.bfloat16) * 0.05)(D, D)),
        }
    _A_in = _A_setup()

    def _B_setup():
        B, S, D = 1, 2048, 512
        ks = 4
        return {
            "q": _w((lambda *s: torch.randn(*s, dtype=torch.bfloat16) * 0.05)(B, S, D)),
            "k": _w((lambda *s: torch.randn(*s, dtype=torch.bfloat16) * 0.4)(B, S, D)),
            "v": _w((lambda *s: torch.randn(*s, dtype=torch.bfloat16) * 0.4)(B, S, D)),
            "shift_k": _w((lambda *s: torch.randn(*s, dtype=torch.bfloat16) * 0.4)(D, ks) * 0.5),
            "ssm_k": _w((lambda *s: torch.randn(*s, dtype=torch.bfloat16) * 0.4)(D, S) * (1.0 / S ** 0.5)),
            "ssm_D": _w((lambda *s: torch.randn(*s, dtype=torch.bfloat16) * 0.4)(D)),
        }
    _B_in = _B_setup()

    return {
        "A_x": _A_in["x"],
        "A_wqkv": _A_in["wqkv"],
        "A_wo": _A_in["wo"],
        "B_q": _B_in["q"],
        "B_k": _B_in["k"],
        "B_v": _B_in["v"],
        "B_shift_k": _B_in["shift_k"],
        "B_ssm_k": _B_in["ssm_k"],
        "B_ssm_D": _B_in["ssm_D"],
    }

def reference(A_x, A_wqkv, A_wo, B_q, B_k, B_v, B_shift_k, B_ssm_k, B_ssm_D):
    def _A_ref(x, wqkv, wo):
        B, S, D = x.shape
        H = 32
        Dh = D // H
        qkv = (lambda x, *d: x.permute(*d))((x @ wqkv).reshape(B, S, 3, H, Dh), 2, 0, 3, 1, 4)
        q, k, v = qkv[0], qkv[1], qkv[2]
        scores = torch.einsum("bhqd,bhkd->bhqk", q, k) * (Dh ** -0.5)
        p = _softmax(scores, axis=-1)
        o = torch.einsum("bhqk,bhkd->bhqd", p, v)
        return (lambda x, *d: x.permute(*d))(o, 0, 2, 1, 3).reshape(B, S, D) @ wo

    def _B_ref(q, k, v, shift_k, ssm_k, ssm_D):
        B, S, D = q.shape
        ks = shift_k.shape[-1]
        k_pad = _pad(k, ((0, 0), (ks - 1, 0), (0, 0)))
        k_shift = torch.zeros_like(k)
        for t in range(ks):
            k_shift = k_shift + k_pad[:, t:t + S, :] * shift_k[:, ks - 1 - t][None, None, :]
        kv = k_shift * v
        L = 2 * S
        kv_pad = _pad(kv, ((0, 0), (0, S), (0, 0)))
        kf_pad = _pad(ssm_k, ((0, 0), (0, S)))
        kv_f = (lambda x, axes=(-2,-1): torch.fft.rfft2(x.float(), dim=axes))(kv_pad[:, None, :, :], axes=(1, 2))
        kf_f = (lambda x, axes=(-2,-1): torch.fft.rfft2(x.float(), dim=axes))(kf_pad[:, None, :], axes=(1, 2))
        kf_f = (lambda x, *d: x.permute(*d))(kf_f, 1, 2, 0)
        y_f = kv_f * kf_f[None, :, :, :]
        y = (lambda x, s, axes=(-2,-1): torch.fft.irfft2(x, s=s, dim=axes).to(torch.bfloat16))(y_f, (1, L), axes=(1, 2))[:, 0, :S, :]
        y = y + kv * ssm_D[None, None, :]
        return q * y

    x = A_x
    x = x + _A_ref(_layernorm(x, axis=-1), A_wqkv, A_wo)
    x = x + _B_ref(_layernorm(x, axis=-1), B_k, B_v, B_shift_k, B_ssm_k, B_ssm_D)
    x = x + _A_ref(_layernorm(x, axis=-1), A_wqkv, A_wo)
    x = x + _B_ref(_layernorm(x, axis=-1), B_k, B_v, B_shift_k, B_ssm_k, B_ssm_D)
    return x
```

```asm
; @launch kernel=k1_kernel grid=(256,1,1) block=(768,1,1) lds=163840
; @launch kernel=a1_kernel grid=(256,1,1) block=(768,1,1) lds=163840
.amdgcn_target "amdgcn-amd-amdhsa--gfx950"
.text
.globl k1_kernel
.p2align 8
.type k1_kernel,@function
k1_kernel:
    s_load_dwordx4 s[4:7], s[0:1], 0
    s_load_dwordx2 s[28:29], s[0:1], 88
    s_mov_b32 s3, 0
J_body:
    s_cmp_ge_u32 s2, 256
    s_cbranch_scc1 J_done
    v_and_b32 v1, 63, v0
    v_lshrrev_b32 v40, 6, v0
    s_nop 0
    v_readfirstlane_b32 s26, v40
    s_and_b32 s30, s2, 7
    s_lshr_b32 s31, s2, 3
    s_and_b32 s23, s30, 3
    s_lshl_b32 s23, s23, 3
    s_and_b32 s32, s31, 7
    s_add_u32 s23, s23, s32
    s_lshr_b32 s24, s30, 2
    s_lshl_b32 s24, s24, 2
    s_lshr_b32 s33, s31, 3
    s_add_u32 s24, s24, s33
    s_and_b32 s20, s26, 3
    s_and_b32 s21, s20, 1
    s_lshr_b32 s22, s20, 1
    s_and_b32 s25, s26, 12
    s_cmp_lg_u32 s25, 4
    s_cbranch_scc1 J_nload
    s_setprio 2
    v_lshrrev_b32 v40, 3, v1
    v_lshrrev_b32 v41, 2, v40
    v_and_b32 v42, 3, v40
    v_lshl_add_u32 v41, v41, 3, v42
    v_lshlrev_b32 v41, 10, v41
    v_and_b32 v42, 7, v1
    v_lshrrev_b32 v43, 1, v40
    v_xor_b32 v43, v42, v43
    s_lshl_b32 s41, s21, 2
    v_xor_b32 v43, s41, v43
    v_lshl_add_u32 v9, v43, 4, v41
    s_movk_i32 s36, 3072
    v_mul_lo_u32 v41, v40, s36
    v_bfe_u32 v43, v1, 4, 1
    v_lshlrev_b32 v43, 2, v43
    v_xor_b32 v43, v42, v43
    v_lshl_add_u32 v10, v43, 4, v41
    s_lshl_b32 s33, s23, 16
    s_lshl_b32 s34, s22, 14
    s_add_u32 s33, s33, s34
    s_lshl_b32 s34, s21, 12
    s_add_u32 s33, s33, s34
    s_lshl_b32 s34, s20, 10
    s_mul_i32 s37, s20, 24576
    s_lshl_b32 s38, s24, 7
    s_add_u32 s37, s37, s38
    s_add_u32 s46, s33, 1024
    s_add_u32 s47, s37, 1572864
    s_lshl_b32 s38, s32, 7
    s_add_u32 s33, s33, s38
    s_mul_i32 s38, s32, 196608
    s_add_u32 s37, s37, s38
    s_add_u32 s38, s34, 65536
    s_mov_b32 s39, 0
    s_mov_b32 s40, s38
    s_add_u32 s42, s38, 86016
    s_mov_b32 s10, 0x200000
    s_mov_b32 s11, 0x20000
    s_mov_b32 s14, 0x180000
    s_mov_b32 s15, 0x20000
    s_lshl_b32 s41, s20, 2
    s_add_u32 s41, s41, 151552
    v_mov_b32 v22, s41
    v_mov_b32 v23, 0
    v_mov_b32 v24, 151568
    s_waitcnt lgkmcnt(0)
    s_add_u32 s8, s28, 0xa00000
    s_addc_u32 s9, s29, 0
    s_cmp_eq_u32 s3, 0
    s_cselect_b32 s8, s4, s8
    s_cselect_b32 s9, s5, s9
    s_mov_b32 s12, s6
    s_mov_b32 s13, s7
J_wl:
    ds_read_b128 v[28:31], v24
    s_bitcmp1_b32 s39, 0
    s_cbranch_scc1 J_wnx
    s_mov_b32 m0, s34
    s_add_u32 s44, s33, 32768
    buffer_load_dwordx4 v9, s[8:11], s33 offen lds
    s_add_u32 s43, s34, 32768
    s_mov_b32 m0, s43
    s_add_u32 s33, s33, 128
    buffer_load_dwordx4 v9, s[8:11], s44 offen lds
    s_add_u32 s34, s34, 4096
    s_sub_u32 s44, s33, 1024
    s_cmp_ge_u32 s33, s46
    s_cselect_b32 s33, s44, s33
J_wnx:
    s_mov_b32 m0, s40
    s_add_u32 s43, s40, 4096
    buffer_load_dwordx4 v10, s[12:15], s37 offen lds
    s_mov_b32 m0, s43
    s_add_u32 s44, s37, 1024
    buffer_load_dwordx4 v10, s[12:15], s44 offen lds
    s_add_u32 s43, s40, 8192
    s_mov_b32 m0, s43
    s_add_u32 s44, s37, 2048
    buffer_load_dwordx4 v10, s[12:15], s44 offen lds
    s_add_u32 s37, s37, 98304
    s_sub_u32 s44, s37, 1572864
    s_cmp_ge_u32 s37, s47
    s_cselect_b32 s37, s44, s37
    s_add_u32 s40, s40, 12288
    s_cmp_eq_u32 s40, s42
    s_cselect_b32 s40, s38, s40
    s_add_u32 s39, s39, 1
    s_cmp_lt_u32 s39, 4
    s_cbranch_scc1 J_wl
    s_cmp_gt_u32 s39, 4
    s_cbranch_scc1 J_wpub
    s_barrier
    s_branch J_wl
J_wpub:
    s_cmp_le_u32 s39, 4
    s_cbranch_scc1 J_wl
    s_sub_u32 s43, s39, 4
    v_max_u32 v23, s43, v23
    s_waitcnt vmcnt(16) lgkmcnt(0)
    ds_write_b32 v22, v23
    s_cmp_lt_u32 s39, 7
    s_cbranch_scc1 J_wl
    s_cmp_ge_u32 s39, 16
    s_cbranch_scc1 J_wend
    s_sub_u32 s43, s39, 7
    v_min3_u32 v28, v28, v29, v30
    v_min_u32 v28, v28, v31
    s_nop 0
    v_readfirstlane_b32 s44, v28
    s_nop 0
    s_cmp_gt_u32 s44, s43
    s_cbranch_scc1 J_wl
    ds_read_b128 v[28:31], v24
    s_sub_u32 s44, s39, 3
    v_max_u32 v23, s44, v23
    s_waitcnt vmcnt(11) lgkmcnt(0)
    ds_write_b32 v22, v23
    v_min3_u32 v28, v28, v29, v30
    v_min_u32 v28, v28, v31
    s_nop 0
    v_readfirstlane_b32 s44, v28
    s_nop 0
    s_cmp_gt_u32 s44, s43
    s_cbranch_scc1 J_wl
    ds_read_b128 v[28:31], v24
    s_sub_u32 s44, s39, 2
    v_max_u32 v23, s44, v23
    s_waitcnt vmcnt(8) lgkmcnt(0)
    ds_write_b32 v22, v23
    v_min3_u32 v28, v28, v29, v30
    v_min_u32 v28, v28, v31
    s_nop 0
    v_readfirstlane_b32 s44, v28
    s_nop 0
    s_cmp_gt_u32 s44, s43
    s_cbranch_scc1 J_wl
J_wspin:
    ds_read_b128 v[28:31], v24
    s_waitcnt lgkmcnt(0)
    v_min3_u32 v28, v28, v29, v30
    v_min_u32 v28, v28, v31
    s_nop 0
    v_readfirstlane_b32 s44, v28
    s_nop 0
    s_cmp_gt_u32 s44, s43
    s_cbranch_scc1 J_wl
    s_branch J_wspin
J_wend:
    v_max_u32 v23, 13, v23
    s_waitcnt vmcnt(11)
    ds_write_b32 v22, v23
    v_max_u32 v23, 14, v23
    s_waitcnt vmcnt(8)
    ds_write_b32 v22, v23
    v_max_u32 v23, 15, v23
    s_waitcnt vmcnt(3)
    ds_write_b32 v22, v23
    v_max_u32 v23, 16, v23
    s_waitcnt vmcnt(0)
    ds_write_b32 v22, v23
    s_endpgm
J_nload:
    v_and_b32 v7, 31, v1
    v_lshrrev_b32 v6, 5, v1
    v_bfe_u32 v41, v7, 1, 3
    v_lshlrev_b32 v42, 7, v7
    s_lshl_b32 s41, s21, 15
    v_add_u32 v42, s41, v42
    v_add_u32 v43, 0, v6
    v_xor_b32 v43, v43, v41
    v_lshl_add_u32 v2, v43, 4, v42
    v_add_u32 v43, 2, v6
    v_xor_b32 v43, v43, v41
    v_lshl_add_u32 v3, v43, 4, v42
    v_add_u32 v43, 4, v6
    v_xor_b32 v43, v43, v41
    v_lshl_add_u32 v4, v43, 4, v42
    v_add_u32 v43, 6, v6
    v_xor_b32 v43, v43, v41
    v_lshl_add_u32 v5, v43, 4, v42
    s_mov_b32 s45, 0xffff0000
    s_cmp_eq_u32 s25, 0
    s_cbranch_scc1 J_compute
    v_lshlrev_b32 v20, 2, v1
    v_add_u32 v20, 151552, v20
    v_mov_b32 v21, 0
    ds_write_b32 v20, v21
    s_lshl_b32 s41, s22, 12
    v_add_u32 v2, s41, v2
    v_add_u32 v3, s41, v3
    v_add_u32 v4, s41, v4
    v_add_u32 v5, s41, v5
    v_mov_b32 v20, 151552
    s_lshl_b32 s27, s22, 1
    v_mov_b32 v8, 0
    v_mov_b32 v9, 0
    v_mov_b32 v10, 0
    v_mov_b32 v11, 0
    s_load_dwordx4 s[36:39], s[0:1], 32
    s_load_dwordx2 s[40:41], s[0:1], 48
    s_mov_b32 s42, 0
    s_waitcnt lgkmcnt(0)
    s_barrier
J_sl:
    s_sleep 2
    ds_read_b128 v[24:27], v20
    s_waitcnt lgkmcnt(0)
    v_min3_u32 v24, v24, v25, v26
    v_min_u32 v24, v24, v27
    s_nop 0
    v_readfirstlane_b32 s44, v24
    s_nop 0
    s_cmp_gt_u32 s44, s27
    s_cbranch_scc0 J_sl
    s_add_u32 s27, s27, 4
    ds_read_b128 v[24:27], v2
    ds_read_b128 v[28:31], v3
    ds_read_b128 v[32:35], v4
    ds_read_b128 v[36:39], v5
    v_add_u32 v2, 0x2000, v2
    v_add_u32 v3, 0x2000, v3
    v_add_u32 v4, 0x2000, v4
    v_add_u32 v5, 0x2000, v5
    s_or_b32 s44, s42, s3
    s_cmp_lg_u32 s44, 0
    s_cbranch_scc1 J_s2
    s_and_b32 s43, s2, 7
    s_lshl_b32 s43, s43, 7
    v_lshl_add_u32 v16, v7, 2, s43
    v_lshlrev_b32 v14, 2, v16
    s_lshr_b32 s46, s2, 3
    s_lshl_b32 s46, s46, 3
    s_lshl_b32 s47, s20, 1
    s_add_u32 s46, s46, s47
    v_add_u32 v17, s46, v6
    v_lshl_add_u32 v12, v17, 13, v16
    v_add_u32 v13, 4096, v12
    v_subrev_u32 v18, 3072, v12
    v_mov_b32 v19, 0x7ffff000
    v_cmp_eq_u32 vcc, 0, v17
    s_nop 1
    v_cndmask_b32 v18, v18, v19, vcc
    s_mov_b32 s8, s36
    s_mov_b32 s9, s37
    s_mov_b32 s10, 0x200000
    s_mov_b32 s11, 0x20000
    s_mov_b32 s12, s38
    s_mov_b32 s13, s39
    s_mov_b32 s14, 0x200000
    s_mov_b32 s15, 0x20000
    s_mov_b32 s48, s40
    s_mov_b32 s49, s41
    s_mov_b32 s50, 0x1000
    s_mov_b32 s51, 0x20000
    buffer_load_dwordx4 v[68:71], v14, s[48:51], 0 offen
    buffer_load_dword v48, v18, s[8:11], 0 offen offset:0
    buffer_load_dword v49, v18, s[8:11], 0 offen offset:1024
    buffer_load_dword v50, v18, s[8:11], 0 offen offset:2048
    buffer_load_dword v51, v12, s[8:11], 0 offen offset:0
    buffer_load_dword v52, v12, s[8:11], 0 offen offset:1024
    buffer_load_dword v53, v12, s[8:11], 0 offen offset:2048
    buffer_load_dword v54, v12, s[8:11], 0 offen offset:3072
    buffer_load_dword v55, v13, s[8:11], 0 offen offset:0
    buffer_load_dword v56, v13, s[8:11], 0 offen offset:1024
    buffer_load_dword v57, v13, s[8:11], 0 offen offset:2048
    buffer_load_dword v58, v13, s[8:11], 0 offen offset:3072
    buffer_load_dword v59, v12, s[12:15], 0 offen offset:0
    buffer_load_dword v60, v12, s[12:15], 0 offen offset:1024
    buffer_load_dword v61, v12, s[12:15], 0 offen offset:2048
    buffer_load_dword v62, v12, s[12:15], 0 offen offset:3072
    buffer_load_dword v63, v13, s[12:15], 0 offen offset:0
    buffer_load_dword v64, v13, s[12:15], 0 offen offset:1024
    buffer_load_dword v65, v13, s[12:15], 0 offen offset:2048
    buffer_load_dword v66, v13, s[12:15], 0 offen offset:3072
    s_mov_b32 s16, s28
    s_mov_b32 s17, s29
    s_mov_b32 s18, 0x2300000
    s_mov_b32 s19, 0x20000
    v_mov_b32 v72, -1
    v_mov_b32 v73, -1
    v_mov_b32 v74, -1
    v_mov_b32 v75, -1
    v_lshlrev_b32 v76, 4, v1
    s_lshl_b32 s43, s2, 13
    s_lshl_b32 s44, s20, 11
    s_add_u32 s43, s43, s44
    s_add_u32 s44, s43, 0x1200000
    buffer_store_dwordx4 v[72:75], v76, s[16:19], s44 offen offset:0 sc1
    buffer_store_dwordx4 v[72:75], v76, s[16:19], s44 offen offset:1024 sc1
J_s2:
    s_waitcnt lgkmcnt(0)
    v_lshlrev_b32 v40, 16, v24
    v_and_b32 v41, s45, v24
    v_add_f32 v8, v8, v40
    v_add_f32 v9, v9, v41
    v_fmac_f32 v10, v40, v40
    v_fmac_f32 v11, v41, v41
    v_lshlrev_b32 v42, 16, v25
    v_and_b32 v43, s45, v25
    v_add_f32 v8, v8, v42
    v_add_f32 v9, v9, v43
    v_fmac_f32 v10, v42, v42
    v_fmac_f32 v11, v43, v43
    v_lshlrev_b32 v40, 16, v26
    v_and_b32 v41, s45, v26
    v_add_f32 v8, v8, v40
    v_add_f32 v9, v9, v41
    v_fmac_f32 v10, v40, v40
    v_fmac_f32 v11, v41, v41
    v_lshlrev_b32 v42, 16, v27
    v_and_b32 v43, s45, v27
    v_add_f32 v8, v8, v42
    v_add_f32 v9, v9, v43
    v_fmac_f32 v10, v42, v42
    v_fmac_f32 v11, v43, v43
    v_lshlrev_b32 v40, 16, v28
    v_and_b32 v41, s45, v28
    v_add_f32 v8, v8, v40
    v_add_f32 v9, v9, v41
    v_fmac_f32 v10, v40, v40
    v_fmac_f32 v11, v41, v41
    v_lshlrev_b32 v42, 16, v29
    v_and_b32 v43, s45, v29
    v_add_f32 v8, v8, v42
    v_add_f32 v9, v9, v43
    v_fmac_f32 v10, v42, v42
    v_fmac_f32 v11, v43, v43
    v_lshlrev_b32 v40, 16, v30
    v_and_b32 v41, s45, v30
    v_add_f32 v8, v8, v40
    v_add_f32 v9, v9, v41
    v_fmac_f32 v10, v40, v40
    v_fmac_f32 v11, v41, v41
    v_lshlrev_b32 v42, 16, v31
    v_and_b32 v43, s45, v31
    v_add_f32 v8, v8, v42
    v_add_f32 v9, v9, v43
    v_fmac_f32 v10, v42, v42
    v_fmac_f32 v11, v43, v43
    v_lshlrev_b32 v40, 16, v32
    v_and_b32 v41, s45, v32
    v_add_f32 v8, v8, v40
    v_add_f32 v9, v9, v41
    v_fmac_f32 v10, v40, v40
    v_fmac_f32 v11, v41, v41
    v_lshlrev_b32 v42, 16, v33
    v_and_b32 v43, s45, v33
    v_add_f32 v8, v8, v42
    v_add_f32 v9, v9, v43
    v_fmac_f32 v10, v42, v42
    v_fmac_f32 v11, v43, v43
    v_lshlrev_b32 v40, 16, v34
    v_and_b32 v41, s45, v34
    v_add_f32 v8, v8, v40
    v_add_f32 v9, v9, v41
    v_fmac_f32 v10, v40, v40
    v_fmac_f32 v11, v41, v41
    v_lshlrev_b32 v42, 16, v35
    v_and_b32 v43, s45, v35
    v_add_f32 v8, v8, v42
    v_add_f32 v9, v9, v43
    v_fmac_f32 v10, v42, v42
    v_fmac_f32 v11, v43, v43
    v_lshlrev_b32 v40, 16, v36
    v_and_b32 v41, s45, v36
    v_add_f32 v8, v8, v40
    v_add_f32 v9, v9, v41
    v_fmac_f32 v10, v40, v40
    v_fmac_f32 v11, v41, v41
    v_lshlrev_b32 v42, 16, v37
    v_and_b32 v43, s45, v37
    v_add_f32 v8, v8, v42
    v_add_f32 v9, v9, v43
    v_fmac_f32 v10, v42, v42
    v_fmac_f32 v11, v43, v43
    v_lshlrev_b32 v40, 16, v38
    v_and_b32 v41, s45, v38
    v_add_f32 v8, v8, v40
    v_add_f32 v9, v9, v41
    v_fmac_f32 v10, v40, v40
    v_fmac_f32 v11, v41, v41
    v_lshlrev_b32 v42, 16, v39
    v_and_b32 v43, s45, v39
    v_add_f32 v8, v8, v42
    v_add_f32 v9, v9, v43
    v_fmac_f32 v10, v42, v42
    v_fmac_f32 v11, v43, v43
    s_add_u32 s42, s42, 1
    s_cmp_lt_u32 s42, 4
    s_cbranch_scc1 J_sl
    v_add_f32 v8, v8, v9
    v_add_f32 v9, v10, v11
    v_mov_b32 v10, v8
    v_mov_b32 v11, v9
    s_lshl_b32 s42, s20, 8
    s_add_u32 s42, s42, 152064
    v_permlane32_swap_b32 v8, v10
    v_permlane32_swap_b32 v9, v11
    v_pk_add_f32 v[8:9], v[8:9], v[10:11]
    v_lshl_add_u32 v20, v7, 3, s42
    ds_write_b64 v20, v[8:9]
    v_mov_b32 v20, 151584
    v_mov_b32 v21, 1
    s_mov_b64 exec, 1
    ds_add_u32 v20, v21
    s_mov_b64 exec, -1
    s_cmp_eq_u32 s3, 1
    s_cbranch_scc1 J_done
    s_movk_i32 s43, 2560
    v_mul_lo_u32 v15, v16, s43
    v_lshlrev_b32 v17, 3, v17
    v_sub_u32 v17, 2040, v17
    v_lshrrev_b32 v18, 5, v17
    v_mul_u32_u24 v18, 80, v18
    v_and_b32 v17, 31, v17
    v_lshl_add_u32 v17, v17, 1, v18
    v_add_u32 v15, v15, v17
    s_mov_b32 s46, 0xe00000
    s_add_u32 s47, s46, 5120
    s_mov_b32 s16, s28
    s_mov_b32 s17, s29
    s_mov_b32 s18, 0x2300000
    s_mov_b32 s19, 0x20000
    s_waitcnt vmcnt(0)
    v_lshlrev_b32 v24, 16, v68
    v_and_b32 v25, s45, v68
    v_lshlrev_b32 v26, 16, v69
    v_and_b32 v27, s45, v69
    v_lshlrev_b32 v72, 16, v48
    v_lshlrev_b32 v73, 16, v49
    v_lshlrev_b32 v74, 16, v50
    v_lshlrev_b32 v75, 16, v51
    v_lshlrev_b32 v76, 16, v52
    v_lshlrev_b32 v77, 16, v53
    v_lshlrev_b32 v78, 16, v54
    v_lshlrev_b32 v79, 16, v55
    v_lshlrev_b32 v80, 16, v56
    v_lshlrev_b32 v81, 16, v57
    v_lshlrev_b32 v82, 16, v58
    v_lshlrev_b32 v84, 16, v59
    v_lshlrev_b32 v85, 16, v60
    v_lshlrev_b32 v86, 16, v61
    v_lshlrev_b32 v87, 16, v62
    v_lshlrev_b32 v88, 16, v63
    v_lshlrev_b32 v89, 16, v64
    v_lshlrev_b32 v90, 16, v65
    v_lshlrev_b32 v91, 16, v66
    v_mul_f32 v92, v27, v72
    v_mul_f32 v93, v27, v73
    v_mul_f32 v94, v27, v74
    v_mul_f32 v95, v27, v75
    v_mul_f32 v96, v27, v76
    v_mul_f32 v97, v27, v77
    v_mul_f32 v98, v27, v78
    v_mul_f32 v99, v27, v79
    v_fmac_f32 v92, v26, v73
    v_fmac_f32 v93, v26, v74
    v_fmac_f32 v94, v26, v75
    v_fmac_f32 v95, v26, v76
    v_fmac_f32 v96, v26, v77
    v_fmac_f32 v97, v26, v78
    v_fmac_f32 v98, v26, v79
    v_fmac_f32 v99, v26, v80
    v_fmac_f32 v92, v25, v74
    v_fmac_f32 v93, v25, v75
    v_fmac_f32 v94, v25, v76
    v_fmac_f32 v95, v25, v77
    v_fmac_f32 v96, v25, v78
    v_fmac_f32 v97, v25, v79
    v_fmac_f32 v98, v25, v80
    v_fmac_f32 v99, v25, v81
    v_fmac_f32 v92, v24, v75
    v_fmac_f32 v93, v24, v76
    v_fmac_f32 v94, v24, v77
    v_fmac_f32 v95, v24, v78
    v_fmac_f32 v96, v24, v79
    v_fmac_f32 v97, v24, v80
    v_fmac_f32 v98, v24, v81
    v_fmac_f32 v99, v24, v82
    v_mul_f32 v92, v92, v84
    v_mul_f32 v93, v93, v85
    v_mul_f32 v94, v94, v86
    v_mul_f32 v95, v95, v87
    v_mul_f32 v96, v96, v88
    v_mul_f32 v97, v97, v89
    v_mul_f32 v98, v98, v90
    v_mul_f32 v99, v99, v91
    v_cvt_pk_bf16_f32 v28, v99, v98
    v_cvt_pk_bf16_f32 v29, v97, v96
    v_cvt_pk_bf16_f32 v30, v95, v94
    v_cvt_pk_bf16_f32 v31, v93, v92
    buffer_store_dwordx4 v[28:31], v15, s[16:19], s46 offen
    v_lshlrev_b32 v24, 16, v70
    v_and_b32 v25, s45, v70
    v_lshlrev_b32 v26, 16, v71
    v_and_b32 v27, s45, v71
    v_and_b32 v72, s45, v48
    v_and_b32 v73, s45, v49
    v_and_b32 v74, s45, v50
    v_and_b32 v75, s45, v51
    v_and_b32 v76, s45, v52
    v_and_b32 v77, s45, v53
    v_and_b32 v78, s45, v54
    v_and_b32 v79, s45, v55
    v_and_b32 v80, s45, v56
    v_and_b32 v81, s45, v57
    v_and_b32 v82, s45, v58
    v_and_b32 v84, s45, v59
    v_and_b32 v85, s45, v60
    v_and_b32 v86, s45, v61
    v_and_b32 v87, s45, v62
    v_and_b32 v88, s45, v63
    v_and_b32 v89, s45, v64
    v_and_b32 v90, s45, v65
    v_and_b32 v91, s45, v66
    v_mul_f32 v92, v27, v72
    v_mul_f32 v93, v27, v73
    v_mul_f32 v94, v27, v74
    v_mul_f32 v95, v27, v75
    v_mul_f32 v96, v27, v76
    v_mul_f32 v97, v27, v77
    v_mul_f32 v98, v27, v78
    v_mul_f32 v99, v27, v79
    v_fmac_f32 v92, v26, v73
    v_fmac_f32 v93, v26, v74
    v_fmac_f32 v94, v26, v75
    v_fmac_f32 v95, v26, v76
    v_fmac_f32 v96, v26, v77
    v_fmac_f32 v97, v26, v78
    v_fmac_f32 v98, v26, v79
    v_fmac_f32 v99, v26, v80
    v_fmac_f32 v92, v25, v74
    v_fmac_f32 v93, v25, v75
    v_fmac_f32 v94, v25, v76
    v_fmac_f32 v95, v25, v77
    v_fmac_f32 v96, v25, v78
    v_fmac_f32 v97, v25, v79
    v_fmac_f32 v98, v25, v80
    v_fmac_f32 v99, v25, v81
    v_fmac_f32 v92, v24, v75
    v_fmac_f32 v93, v24, v76
    v_fmac_f32 v94, v24, v77
    v_fmac_f32 v95, v24, v78
    v_fmac_f32 v96, v24, v79
    v_fmac_f32 v97, v24, v80
    v_fmac_f32 v98, v24, v81
    v_fmac_f32 v99, v24, v82
    v_mul_f32 v92, v92, v84
    v_mul_f32 v93, v93, v85
    v_mul_f32 v94, v94, v86
    v_mul_f32 v95, v95, v87
    v_mul_f32 v96, v96, v88
    v_mul_f32 v97, v97, v89
    v_mul_f32 v98, v98, v90
    v_mul_f32 v99, v99, v91
    v_cvt_pk_bf16_f32 v32, v99, v98
    v_cvt_pk_bf16_f32 v33, v97, v96
    v_cvt_pk_bf16_f32 v34, v95, v94
    v_cvt_pk_bf16_f32 v35, v93, v92
    buffer_store_dwordx4 v[32:35], v15, s[16:19], s47 offen
    s_endpgm
J_compute:
    s_setprio 1
    v_bfe_u32 v41, v1, 2, 2
    v_lshl_add_u32 v42, v6, 3, v41
    v_lshlrev_b32 v42, 7, v42
    v_and_b32 v43, 1, v1
    v_bfe_u32 v44, v1, 1, 1
    v_lshl_add_u32 v43, v43, 1, v44
    v_lshlrev_b32 v43, 3, v43
    v_bfe_u32 v44, v1, 4, 1
    v_lshl_add_u32 v43, v44, 5, v43
    s_lshl_b32 s41, s22, 6
    v_add_u32 v43, s41, v43
    v_lshrrev_b32 v44, 1, v41
    v_lshlrev_b32 v44, 6, v44
    v_xor_b32 v43, v43, v44
    s_lshl_b32 s41, s21, 11
    s_add_u32 s41, s41, 65536
    v_add3_u32 v10, v42, v43, s41
    v_mov_b32 v8, v10
    v_xor_b32 v9, 0x800, v10
    s_lshl_b32 s41, s21, 5
    v_xor_b32 v2, s41, v2
    v_xor_b32 v3, s41, v3
    v_xor_b32 v4, s41, v4
    v_xor_b32 v5, s41, v5
    v_mov_b32 v11, 151552
    s_lshl_b32 s41, s20, 2
    s_add_u32 s41, s41, 151568
    v_mov_b32 v12, s41
    v_mov_b32 v13, 1
    v_cmp_eq_u32 vcc, 0, v7
    v_cmp_eq_u32 s[46:47], 20, v7
    v_mov_b32 v41, 0x3f803f80
    s_or_b64 vcc, vcc, s[46:47]
    v_cndmask_b32 v48, 0, v41, vcc
    v_mov_b32 v49, v48
    v_mov_b32 v50, v48
    v_mov_b32 v51, v48
    v_and_b32 v41, 0x13, v7
    v_lshrrev_b32 v42, 1, v7
    v_and_b32 v42, 4, v42
    v_or_b32 v41, v41, v42
    v_lshlrev_b32 v42, 1, v7
    v_and_b32 v42, 8, v42
    v_or_b32 v14, v41, v42
    s_barrier
    v_mov_b32 v52, 0
    v_mov_b32 v53, 0
    v_mov_b32 v54, 0
    v_mov_b32 v55, 0
    v_mov_b32 v56, 0
    v_mov_b32 v57, 0
    v_mov_b32 v58, 0
    v_mov_b32 v59, 0
    v_mov_b32 v60, 0
    v_mov_b32 v61, 0
    v_mov_b32 v62, 0
    v_mov_b32 v63, 0
    v_mov_b32 v64, 0
    v_mov_b32 v65, 0
    v_mov_b32 v66, 0
    v_mov_b32 v67, 0
    v_mov_b32 v68, 0
    v_mov_b32 v69, 0
    v_mov_b32 v70, 0
    v_mov_b32 v71, 0
    v_mov_b32 v72, 0
    v_mov_b32 v73, 0
    v_mov_b32 v74, 0
    v_mov_b32 v75, 0
    v_mov_b32 v76, 0
    v_mov_b32 v77, 0
    v_mov_b32 v78, 0
    v_mov_b32 v79, 0
    v_mov_b32 v80, 0
    v_mov_b32 v81, 0
    v_mov_b32 v82, 0
    v_mov_b32 v83, 0
    v_mov_b32 v84, 0
    v_mov_b32 v85, 0
    v_mov_b32 v86, 0
    v_mov_b32 v87, 0
    v_mov_b32 v88, 0
    v_mov_b32 v89, 0
    v_mov_b32 v90, 0
    v_mov_b32 v91, 0
    v_mov_b32 v92, 0
    v_mov_b32 v93, 0
    v_mov_b32 v94, 0
    v_mov_b32 v95, 0
    v_mov_b32 v96, 0
    v_mov_b32 v97, 0
    v_mov_b32 v98, 0
    v_mov_b32 v99, 0
    v_mov_b32 v100, 0
    v_mov_b32 v101, 0
    v_mov_b32 v102, 0
    v_mov_b32 v103, 0
    v_mov_b32 v104, 0
    v_mov_b32 v105, 0
    v_mov_b32 v106, 0
    v_mov_b32 v107, 0
    v_mov_b32 v108, 0
    v_mov_b32 v109, 0
    v_mov_b32 v110, 0
    v_mov_b32 v111, 0
    s_mov_b32 s40, 12288
    s_mov_b32 s43, 1
J_c0:
    ds_read_b128 v[120:123], v11
    s_waitcnt lgkmcnt(0)
    v_min3_u32 v120, v120, v121, v122
    v_min_u32 v120, v120, v123
    s_nop 0
    v_readfirstlane_b32 s44, v120
    s_nop 0
    s_cmp_eq_u32 s44, 0
    s_cbranch_scc1 J_c0
    ds_read_b64_tr_b16 v[16:17], v8 offset:0
    ds_read_b64_tr_b16 v[18:19], v8 offset:512
    ds_read_b128 v[40:43], v2
    ds_read_b128 v[44:47], v3
    ds_read_b64_tr_b16 v[20:21], v8 offset:4096
    ds_read_b64_tr_b16 v[22:23], v8 offset:4608
    ds_read_b64_tr_b16 v[24:25], v8 offset:8192
    ds_read_b64_tr_b16 v[26:27], v8 offset:8704
    ds_read_b128 v[120:123], v11
    ds_read_b64_tr_b16 v[28:29], v9 offset:0
    ds_read_b64_tr_b16 v[30:31], v9 offset:512
    ds_read_b64_tr_b16 v[32:33], v9 offset:4096
    ds_read_b64_tr_b16 v[34:35], v9 offset:4608
.p2align 6
J_loop:
    s_waitcnt lgkmcnt(9)
    v_mfma_f32_32x32x16_bf16 v[64:79], v[16:19], v[40:43], v[64:79]
    ds_read_b64_tr_b16 v[36:37], v9 offset:8192
    ds_read_b64_tr_b16 v[38:39], v9 offset:8704
    ds_write_b32 v12, v13
    s_waitcnt lgkmcnt(7)
    v_min3_u32 v120, v120, v121, v122
    v_min_u32 v120, v120, v123
    v_mfma_f32_16x16x32_bf16 v[52:55], v[48:51], v[16:19], v[52:55]
    v_mfma_f32_32x32x16_bf16 v[80:95], v[20:23], v[40:43], v[80:95]
    v_readfirstlane_b32 s44, v120
    v_add_u32 v8, s40, v10
    v_add_u32 v13, 1, v13
    s_add_u32 s40, s40, 12288
    s_cmp_gt_u32 s44, s43
    s_cbranch_scc0 J_fs0
J_fk0:
    ds_read_b64_tr_b16 v[16:17], v8 offset:0
    ds_read_b64_tr_b16 v[18:19], v8 offset:512
    v_mfma_f32_16x16x32_bf16 v[56:59], v[48:51], v[20:23], v[56:59]
    v_mfma_f32_32x32x16_bf16 v[96:111], v[40:43], v[24:27], v[96:111]
    ds_read_b128 v[112:115], v4 offset:0
    ds_read_b128 v[116:119], v5 offset:0
    ds_read_b64_tr_b16 v[20:21], v8 offset:4096
    ds_read_b64_tr_b16 v[22:23], v8 offset:4608
    v_xor_b32 v9, 0x800, v8
    v_mfma_f32_16x16x32_bf16 v[60:63], v[48:51], v[24:27], v[60:63]
    s_waitcnt lgkmcnt(9)
    v_mfma_f32_32x32x16_bf16 v[64:79], v[28:31], v[44:47], v[64:79]
    ds_read_b64_tr_b16 v[24:25], v8 offset:8192
    ds_read_b64_tr_b16 v[26:27], v8 offset:8704
    ds_read_b128 v[120:123], v11
    s_cmp_eq_u32 s40, 86016
    s_cselect_b32 s40, 0, s40
    s_add_u32 s43, s43, 1
    v_mfma_f32_32x32x16_bf16 v[80:95], v[32:35], v[44:47], v[80:95]
    ds_read_b64_tr_b16 v[28:29], v9 offset:0
    ds_read_b64_tr_b16 v[30:31], v9 offset:512
    s_waitcnt lgkmcnt(12)
    v_mfma_f32_32x32x16_bf16 v[96:111], v[44:47], v[36:39], v[96:111]
    ds_read_b64_tr_b16 v[32:33], v9 offset:4096
    ds_read_b64_tr_b16 v[34:35], v9 offset:4608
    s_waitcnt lgkmcnt(9)
    v_mfma_f32_32x32x16_bf16 v[64:79], v[16:19], v[112:115], v[64:79]
    ds_read_b64_tr_b16 v[36:37], v9 offset:8192
    ds_read_b64_tr_b16 v[38:39], v9 offset:8704
    ds_write_b32 v12, v13
    s_waitcnt lgkmcnt(7)
    v_min3_u32 v120, v120, v121, v122
    v_min_u32 v120, v120, v123
    v_mfma_f32_16x16x32_bf16 v[52:55], v[48:51], v[16:19], v[52:55]
    v_mfma_f32_32x32x16_bf16 v[80:95], v[20:23], v[112:115], v[80:95]
    v_readfirstlane_b32 s44, v120
    v_add_u32 v8, s40, v10
    v_add_u32 v13, 1, v13
    s_add_u32 s40, s40, 12288
    s_cmp_gt_u32 s44, s43
    s_cbranch_scc0 J_fs1
J_fk1:
    ds_read_b64_tr_b16 v[16:17], v8 offset:0
    ds_read_b64_tr_b16 v[18:19], v8 offset:512
    v_mfma_f32_16x16x32_bf16 v[56:59], v[48:51], v[20:23], v[56:59]
    v_mfma_f32_32x32x16_bf16 v[96:111], v[112:115], v[24:27], v[96:111]
    ds_read_b128 v[40:43], v2 offset:4096
    ds_read_b128 v[44:47], v3 offset:4096
    ds_read_b64_tr_b16 v[20:21], v8 offset:4096
    ds_read_b64_tr_b16 v[22:23], v8 offset:4608
    v_xor_b32 v9, 0x800, v8
    v_mfma_f32_16x16x32_bf16 v[60:63], v[48:51], v[24:27], v[60:63]
    s_waitcnt lgkmcnt(9)
    v_mfma_f32_32x32x16_bf16 v[64:79], v[28:31], v[116:119], v[64:79]
    ds_read_b64_tr_b16 v[24:25], v8 offset:8192
    ds_read_b64_tr_b16 v[26:27], v8 offset:8704
    ds_read_b128 v[120:123], v11
    s_cmp_eq_u32 s40, 86016
    s_cselect_b32 s40, 0, s40
    s_add_u32 s43, s43, 1
    v_mfma_f32_32x32x16_bf16 v[80:95], v[32:35], v[116:119], v[80:95]
    ds_read_b64_tr_b16 v[28:29], v9 offset:0
    ds_read_b64_tr_b16 v[30:31], v9 offset:512
    v_add_u32 v2, 0x1000, v2
    v_add_u32 v3, 0x1000, v3
    v_add_u32 v4, 0x1000, v4
    v_add_u32 v5, 0x1000, v5
    s_waitcnt lgkmcnt(12)
    v_mfma_f32_32x32x16_bf16 v[96:111], v[116:119], v[36:39], v[96:111]
    ds_read_b64_tr_b16 v[32:33], v9 offset:4096
    ds_read_b64_tr_b16 v[34:35], v9 offset:4608
    s_cmp_lt_u32 s43, 17
    s_cbranch_scc1 J_loop
    s_mov_b32 s16, s28
    s_mov_b32 s17, s29
    s_mov_b32 s18, 0x2300000
    s_mov_b32 s19, 0x20000
    v_mov_b32 v11, 151584
    s_lshl_b32 s41, s21, 8
    s_add_u32 s41, s41, 152064
    v_lshl_add_u32 v8, v7, 3, s41
    s_lshl_b32 s41, s20, 10
    s_add_u32 s41, s41, 155648
    v_lshl_add_u32 v9, v1, 2, s41
    v_xor_b32 v10, 0x400, v9
    v_mov_b32 v13, 1
    ds_write_b32 v9, v52 offset:0
    ds_write_b32 v9, v56 offset:256
    ds_write_b32 v9, v60 offset:512
    s_mov_b64 exec, 1
    ds_add_u32 v11, v13
    s_mov_b64 exec, -1
    s_lshl_b32 s43, s24, 2
    s_lshl_b32 s44, s22, 1
    s_add_u32 s43, s43, s44
    s_lshl_b32 s42, s23, 1
    s_add_u32 s42, s42, s21
    s_lshl_b32 s30, s43, 16
    s_lshl_b32 s31, s42, 10
    s_add_u32 s30, s30, s31
    s_add_u32 s31, s30, 65536
    s_lshl_b32 s32, s30, 1
    s_add_u32 s32, s32, 0x200000
    s_add_u32 s33, s32, 131072
J_es:
    ds_read_b32 v120, v11
    ds_read_b64 v[112:113], v8
    ds_read_b64 v[114:115], v8 offset:512
    ds_read_b32 v53, v10 offset:0
    ds_read_b32 v57, v10 offset:256
    ds_read_b32 v61, v10 offset:512
    s_waitcnt lgkmcnt(0)
    v_readfirstlane_b32 s44, v120
    s_nop 0
    s_cmp_lt_u32 s44, 8
    s_cbranch_scc1 J_es
    v_add_f32 v52, v52, v53
    v_cvt_pk_bf16_f32 v116, v52, v52
    v_lshlrev_b32 v116, 16, v116
    v_sub_f32 v117, v52, v116
    v_cvt_pk_bf16_f32 v16, v116, v117
    v_add_f32 v56, v56, v57
    v_cvt_pk_bf16_f32 v116, v56, v56
    v_lshlrev_b32 v116, 16, v116
    v_sub_f32 v117, v56, v116
    v_cvt_pk_bf16_f32 v20, v116, v117
    v_add_f32 v60, v60, v61
    v_cvt_pk_bf16_f32 v116, v60, v60
    v_lshlrev_b32 v116, 16, v116
    v_sub_f32 v117, v60, v116
    v_cvt_pk_bf16_f32 v24, v116, v117
    s_or_b32 s44, s23, s21
    s_cmp_lg_u32 s44, 0
    s_cbranch_scc1 J_ncs
    s_lshl_b32 s44, s24, 1
    s_add_u32 s44, s44, s22
    s_mul_i32 s44, s44, 384
    s_add_u32 s44, s44, 0xc90000
    v_lshlrev_b32 v116, 2, v1
    s_mov_b32 exec_hi, 0
    buffer_store_dword v52, v116, s[16:19], s44 offen offset:0
    buffer_store_dword v56, v116, s[16:19], s44 offen offset:128
    buffer_store_dword v60, v116, s[16:19], s44 offen offset:256
    s_mov_b32 exec_hi, -1
J_ncs:
    v_pk_add_f32 v[112:113], v[112:113], v[114:115]
    v_mul_f32 v112, 0x3b000000, v112
    v_cvt_pk_bf16_f32 v40, -v112, -v112
    v_mov_b32 v41, 0
    v_mov_b32 v42, 0
    v_mov_b32 v43, 0
    v_mul_f32 v113, 0x3b000000, v113
    v_fma_f32 v113, -v112, v112, v113
    v_mfma_f32_32x32x16_bf16 v[64:79], v[16:19], v[40:43], v[64:79]
    v_mfma_f32_32x32x16_bf16 v[80:95], v[20:23], v[40:43], v[80:95]
    v_mfma_f32_32x32x16_bf16 v[96:111], v[40:43], v[24:27], v[96:111]
    v_max_f32 v113, 0, v113
    v_cvt_pk_bf16_f32 v116, v113, v113
    v_lshlrev_b32 v116, 16, v116
    v_add_f32 v116, 0x3727c5ac, v116
    v_cvt_pk_bf16_f32 v116, v116, v116
    v_lshlrev_b32 v116, 16, v116
    v_sqrt_f32 v116, v116
    s_lshl_b32 s41, s20, 7
    v_cvt_pk_bf16_f32 v116, v116, v116
    v_lshlrev_b32 v116, 16, v116
    v_rcp_f32 v114, v116
    s_add_u32 s41, s41, 153088
    v_lshl_add_u32 v116, v14, 2, s41
    ds_write_b32 v116, v114
    v_mov_b32 v115, v114
    v_lshlrev_b32 v116, 5, v6
    v_add_u32 v116, s41, v116
    v_lshlrev_b32 v117, 9, v6
    v_lshl_add_u32 v117, v14, 4, v117
    v_mul_f32 v112, 0x3eb8aa3b, v114
    v_mul_f32 v113, 0x3eb8aa3b, v114
    s_waitcnt lgkmcnt(0)
    ds_read_b128 v[48:51], v116
    ds_read_b128 v[52:55], v116 offset:16
    ds_read_b128 v[56:59], v116 offset:64
    ds_read_b128 v[60:63], v116 offset:80
    v_pk_mul_f32 v[64:65], v[64:65], v[112:113]
    v_pk_mul_f32 v[66:67], v[66:67], v[112:113]
    v_pk_mul_f32 v[68:69], v[68:69], v[112:113]
    v_pk_mul_f32 v[70:71], v[70:71], v[112:113]
    v_pk_mul_f32 v[72:73], v[72:73], v[112:113]
    v_pk_mul_f32 v[74:75], v[74:75], v[112:113]
    v_pk_mul_f32 v[76:77], v[76:77], v[112:113]
    v_pk_mul_f32 v[78:79], v[78:79], v[112:113]
    v_cvt_pk_bf16_f32 v16, v64, v65
    v_cvt_pk_bf16_f32 v17, v66, v67
    v_cvt_pk_bf16_f32 v18, v68, v69
    v_cvt_pk_bf16_f32 v19, v70, v71
    v_cvt_pk_bf16_f32 v20, v72, v73
    v_cvt_pk_bf16_f32 v21, v74, v75
    v_cvt_pk_bf16_f32 v22, v76, v77
    v_cvt_pk_bf16_f32 v23, v78, v79
    buffer_store_dwordx4 v[16:19], v117, s[16:19], s30 offen sc1
    buffer_store_dwordx4 v[20:23], v117, s[16:19], s31 offen sc1
    v_pk_mul_f32 v[80:81], v[80:81], v[114:115]
    v_pk_mul_f32 v[82:83], v[82:83], v[114:115]
    v_pk_mul_f32 v[84:85], v[84:85], v[114:115]
    v_pk_mul_f32 v[86:87], v[86:87], v[114:115]
    v_pk_mul_f32 v[88:89], v[88:89], v[114:115]
    v_pk_mul_f32 v[90:91], v[90:91], v[114:115]
    v_pk_mul_f32 v[92:93], v[92:93], v[114:115]
    v_pk_mul_f32 v[94:95], v[94:95], v[114:115]
    v_cvt_pk_bf16_f32 v24, v80, v81
    v_cvt_pk_bf16_f32 v25, v82, v83
    v_cvt_pk_bf16_f32 v26, v84, v85
    v_cvt_pk_bf16_f32 v27, v86, v87
    v_cvt_pk_bf16_f32 v28, v88, v89
    v_cvt_pk_bf16_f32 v29, v90, v91
    v_cvt_pk_bf16_f32 v30, v92, v93
    v_cvt_pk_bf16_f32 v31, v94, v95
    buffer_store_dwordx4 v[24:27], v117, s[16:19], s32 offen sc1
    buffer_store_dwordx4 v[28:31], v117, s[16:19], s33 offen sc1
    v_bfe_u32 v116, v1, 4, 1
    v_lshlrev_b32 v116, 17, v116
    v_lshl_add_u32 v116, v6, 8, v116
    v_and_b32 v117, 15, v1
    v_lshl_add_u32 v116, v117, 4, v116
    s_waitcnt lgkmcnt(0)
    v_pk_mul_f32 v[96:97], v[96:97], v[48:49]
    v_pk_mul_f32 v[98:99], v[98:99], v[50:51]
    v_pk_mul_f32 v[100:101], v[100:101], v[52:53]
    v_pk_mul_f32 v[102:103], v[102:103], v[54:55]
    v_pk_mul_f32 v[104:105], v[104:105], v[56:57]
    v_pk_mul_f32 v[106:107], v[106:107], v[58:59]
    v_pk_mul_f32 v[108:109], v[108:109], v[60:61]
    v_pk_mul_f32 v[110:111], v[110:111], v[62:63]
    v_cvt_pk_bf16_f32 v32, v96, v97
    v_cvt_pk_bf16_f32 v33, v98, v99
    v_cvt_pk_bf16_f32 v34, v100, v101
    v_cvt_pk_bf16_f32 v35, v102, v103
    v_cvt_pk_bf16_f32 v36, v104, v105
    v_cvt_pk_bf16_f32 v37, v106, v107
    v_cvt_pk_bf16_f32 v38, v108, v109
    v_cvt_pk_bf16_f32 v39, v110, v111
    buffer_store_dwordx4 v[32:35], v116, s[16:19], s32 offen offset:1024 sc1
    buffer_store_dwordx4 v[36:39], v116, s[16:19], s32 offen offset:1536 sc1
    v_mov_b32 v112, 0
    v_mov_b32 v113, 0
    v_dot2c_f32_bf16 v112, v24, v24
    v_dot2c_f32_bf16 v113, v28, v28
    v_dot2c_f32_bf16 v112, v25, v25
    v_dot2c_f32_bf16 v113, v29, v29
    v_dot2c_f32_bf16 v112, v26, v26
    v_dot2c_f32_bf16 v113, v30, v30
    v_dot2c_f32_bf16 v112, v27, v27
    v_dot2c_f32_bf16 v113, v31, v31
    s_lshl_b32 s30, s43, 8
    s_lshl_b32 s31, s42, 2
    s_add_u32 s30, s30, s31
    v_permlane32_swap_b32 v112, v113
    v_add_f32 v112, v112, v113
    s_nop 1
    v_max_f32_dpp v112, v112, v112 row_ror:8 row_mask:0xf bank_mask:0xf
    s_nop 1
    v_max_f32_dpp v112, v112, v112 row_ror:4 row_mask:0xf bank_mask:0xf
    s_nop 1
    v_max_f32_dpp v112, v112, v112 row_ror:2 row_mask:0xf bank_mask:0xf
    s_nop 1
    v_max_f32_dpp v112, v112, v112 row_ror:1 row_mask:0xf bank_mask:0xf
    v_mov_b32 v113, v112
    v_lshlrev_b32 v116, 8, v6
    s_add_u32 s30, s30, 0xc80000
    v_permlane16_swap_b32 v112, v113
    v_max_f32 v112, v112, v113
    s_mov_b32 s46, 1
    s_mov_b32 s47, 1
    s_mov_b64 exec, s[46:47]
    buffer_store_dword v112, v116, s[16:19], s30 offen
    s_cmp_lg_u32 s26, 0
    s_cbranch_scc1 J_noclr
    s_mov_b64 exec, -1
    v_mov_b32 v64, -1
    v_mov_b32 v65, -1
    v_mov_b32 v66, -1
    v_mov_b32 v67, -1
    v_lshlrev_b32 v68, 4, v1
    s_lshl_b32 s30, s2, 10
    s_add_u32 s31, s30, 0x10000
    s_cmp_ge_u32 s2, 192
    s_cselect_b32 s30, s31, s30
    s_add_u32 s30, s30, 0xd00000
    buffer_store_dwordx4 v[64:67], v68, s[16:19], s30 offen
J_noclr:
J_done:
    s_endpgm
J_fs0:
    s_cmp_ge_u32 s43, 16
    s_cbranch_scc1 J_fk0
    ds_read_b128 v[120:123], v11
    s_waitcnt lgkmcnt(0)
    v_min3_u32 v120, v120, v121, v122
    v_min_u32 v120, v120, v123
    s_nop 0
    v_readfirstlane_b32 s44, v120
    s_nop 0
    s_cmp_gt_u32 s44, s43
    s_cbranch_scc1 J_fk0
    s_branch J_fs0
J_fs1:
    s_cmp_ge_u32 s43, 16
    s_cbranch_scc1 J_fk1
    ds_read_b128 v[120:123], v11
    s_waitcnt lgkmcnt(0)
    v_min3_u32 v120, v120, v121, v122
    v_min_u32 v120, v120, v123
    s_nop 0
    v_readfirstlane_b32 s44, v120
    s_nop 0
    s_cmp_gt_u32 s44, s43
    s_cbranch_scc1 J_fk1
    s_branch J_fs1
.globl a1_kernel
.p2align 8
.type a1_kernel,@function
a1_kernel:
    s_mov_b32 s3, 0
    s_load_dwordx2 s[28:29], s[0:1], 88
    s_cmp_ge_u32 s2, 256
    s_cbranch_scc1 A_done
    v_and_b32 v1, 63, v0
    v_lshrrev_b32 v100, 6, v0
    s_nop 0
    v_readfirstlane_b32 s20, v100
A_again:
    s_mul_i32 s49, s3, 0x1600000
    v_lshlrev_b32 v97, 4, v1
    s_and_b32 s30, s2, 7
    s_lshl_b32 s21, s30, 2
    s_lshr_b32 s31, s2, 6
    s_add_u32 s21, s21, s31
    s_mov_b32 s18, 0x2300000
    s_mov_b32 s19, 0x20000
    s_cmp_ge_u32 s20, 8
    s_cbranch_scc1 A_loader
    s_lshr_b32 s22, s2, 3
    s_and_b32 s22, s22, 7
    s_lshl_b32 s22, s22, 3
    s_add_u32 s22, s22, s20
    v_lshlrev_b32 v101, 2, v1
    s_lshl_b32 s23, s21, 16
    s_lshl_b32 s24, s22, 10
    s_add_u32 s23, s23, s24
    s_add_u32 s23, s23, s49
    s_lshl_b32 s24, s21, 8
    s_add_u32 s24, s24, s49
    s_add_u32 s24, s24, 0xc80000
    s_waitcnt lgkmcnt(0)
    s_mov_b32 s16, s28
    s_mov_b32 s17, s29
    buffer_load_dwordx4 v[4:7], v97, s[16:19], s23 offen
    buffer_load_dword v102, v101, s[16:19], s24 offen
    v_lshrrev_b32 v100, 5, v1
    v_and_b32 v101, 15, v1
    v_lshlrev_b32 v101, 4, v101
    v_lshl_add_u32 v99, v100, 8, v101
    v_add_u32 v99, 1024, v99
    v_mov_b32 v96, 0xdddddddd
    v_and_b32 v101, 27, v1
    v_cmp_eq_u32 vcc, 16, v101
    v_mov_b32 v101, 0x3f803f80
    s_nop 0
    v_cndmask_b32 v80, 0, v101, vcc
    v_mov_b32 v81, v80
    v_mov_b32 v82, v80
    v_mov_b32 v83, v80
    v_mov_b32 v84, v80
    v_mov_b32 v85, v80
    v_mov_b32 v86, v80
    v_mov_b32 v87, v80
    v_mov_b32 v88, v80
    v_mov_b32 v89, v80
    v_mov_b32 v90, v80
    v_mov_b32 v91, v80
    v_mov_b32 v92, v80
    v_mov_b32 v93, v80
    v_mov_b32 v94, v80
    v_mov_b32 v95, v80
    s_mov_b32 s32, 0x0000ffff
    s_mov_b32 s33, 0x0000ffff
    s_mov_b32 s34, 0
    s_mov_b32 s37, 1
    v_mov_b32 v103, 0
    s_waitcnt vmcnt(0)
    v_dot2c_f32_bf16 v103, v4, v4
    v_dot2c_f32_bf16 v103, v5, v5
    v_dot2c_f32_bf16 v103, v6, v6
    v_dot2c_f32_bf16 v103, v7, v7
    v_max_f32_dpp v102, v102, v102 row_ror:8 row_mask:0xf bank_mask:0xf
    s_nop 1
    v_max_f32_dpp v102, v102, v102 row_ror:4 row_mask:0xf bank_mask:0xf
    s_nop 1
    v_max_f32_dpp v102, v102, v102 row_ror:2 row_mask:0xf bank_mask:0xf
    s_nop 1
    v_max_f32_dpp v102, v102, v102 row_ror:1 row_mask:0xf bank_mask:0xf
    v_mov_b32 v104, v103
    v_mov_b32 v105, v102
    s_nop 0
    v_permlane32_swap_b32 v103, v104
    v_permlane16_swap_b32 v102, v105
    v_add_f32 v103, v103, v104
    v_max_f32 v102, v102, v105
    v_mov_b32 v105, v102
    s_nop 1
    v_permlane32_swap_b32 v102, v105
    v_max_f32 v102, v102, v105
    v_mul_f32 v103, v103, v102
    v_sqrt_f32 v103, v103
    s_nop 0
    v_mul_f32 v103, 0xbf8020c5, v103
    v_mov_b32 v8, v103
    v_mov_b32 v9, v103
    v_mov_b32 v10, v103
    v_mov_b32 v11, v103
    v_mov_b32 v12, v103
    v_mov_b32 v13, v103
    v_mov_b32 v14, v103
    v_mov_b32 v15, v103
    v_mov_b32 v16, v103
    v_mov_b32 v17, v103
    v_mov_b32 v18, v103
    v_mov_b32 v19, v103
    v_mov_b32 v20, v103
    v_mov_b32 v21, v103
    v_mov_b32 v22, v103
    v_mov_b32 v23, v103
    s_barrier
A_start:
    v_lshlrev_b32 v97, 4, v1
    v_mov_b32 v98, v99
    ds_read_b128 v[72:75], v97 offset:0
    s_mov_b64 exec, s[32:33]
    ds_read_b128 v[80:83], v98 offset:0
    ds_read_b128 v[84:87], v98 offset:512
    s_mov_b64 exec, -1
    ds_read_b128 v[76:79], v97 offset:2048
    v_mov_b32 v56, 0
    v_mov_b32 v57, 0
    v_mov_b32 v58, 0
    v_mov_b32 v59, 0
    v_mov_b32 v60, 0
    v_mov_b32 v61, 0
    v_mov_b32 v62, 0
    v_mov_b32 v63, 0
    v_mov_b32 v64, 0
    v_mov_b32 v65, 0
    v_mov_b32 v66, 0
    v_mov_b32 v67, 0
    v_mov_b32 v68, 0
    v_mov_b32 v69, 0
    v_mov_b32 v70, 0
    v_mov_b32 v71, 0
    v_mov_b32 v48, 0
    v_mov_b32 v49, 0
    v_mov_b32 v50, 0
    v_mov_b32 v51, 0
    v_mov_b32 v52, 0
    v_mov_b32 v53, 0
    v_mov_b32 v54, 0
    v_mov_b32 v55, 0
    s_mov_b32 s35, 0
    s_mov_b32 s38, 1
    s_waitcnt lgkmcnt(3)
    v_mfma_f32_32x32x16_bf16 v[24:39], v[72:75], v[4:7], v[8:23]
    s_nop 7
    s_nop 3
.p2align 6
A_loop:
    s_cmp_lt_u32 s37, s38
    s_cbranch_scc1 A_sync
A_loop2:
    v_exp_f32 v24, v24
    v_exp_f32 v25, v25
    v_smfmac_f32_32x32x32_bf16 v[56:71], v[92:95], v[48:55], v96
    s_mov_b64 exec, s[32:33]
    ds_read_b128 v[88:91], v98 offset:2048
    ds_read_b128 v[92:95], v98 offset:2560
    s_mov_b64 exec, -1
    ds_read_b128 v[72:75], v97 offset:4096
    v_exp_f32 v26, v26
    v_exp_f32 v27, v27
    v_exp_f32 v28, v28
    v_exp_f32 v29, v29
    s_waitcnt lgkmcnt(3)
    v_mfma_f32_32x32x16_bf16 v[40:55], v[76:79], v[4:7], v[8:23]
    v_exp_f32 v30, v30
    v_exp_f32 v31, v31
    v_exp_f32 v32, v32
    v_exp_f32 v33, v33
    v_smfmac_f32_32x32x32_bf16 v[56:71], v[80:83], v[24:31], v96
    s_nop 0
    v_exp_f32 v34, v34
    v_exp_f32 v35, v35
    v_exp_f32 v36, v36
    v_exp_f32 v37, v37
    v_exp_f32 v38, v38
    v_exp_f32 v39, v39
    v_exp_f32 v40, v40
    v_exp_f32 v41, v41
    v_smfmac_f32_32x32x32_bf16 v[56:71], v[84:87], v[32:39], v96
    s_mov_b64 exec, s[32:33]
    ds_read_b128 v[80:83], v98 offset:4096
    ds_read_b128 v[84:87], v98 offset:4608
    s_mov_b64 exec, -1
    ds_read_b128 v[76:79], v97 offset:6144
    v_exp_f32 v42, v42
    v_exp_f32 v43, v43
    v_exp_f32 v44, v44
    v_exp_f32 v45, v45
    s_waitcnt lgkmcnt(3)
    v_mfma_f32_32x32x16_bf16 v[24:39], v[72:75], v[4:7], v[8:23]
    v_exp_f32 v46, v46
    v_exp_f32 v47, v47
    v_exp_f32 v48, v48
    v_exp_f32 v49, v49
    v_smfmac_f32_32x32x32_bf16 v[56:71], v[88:91], v[40:47], v96
    s_nop 0
    v_exp_f32 v50, v50
    v_exp_f32 v51, v51
    v_exp_f32 v52, v52
    v_exp_f32 v53, v53
    v_exp_f32 v54, v54
    v_exp_f32 v55, v55
    v_exp_f32 v24, v24
    v_exp_f32 v25, v25
    v_smfmac_f32_32x32x32_bf16 v[56:71], v[92:95], v[48:55], v96
    s_mov_b64 exec, s[32:33]
    ds_read_b128 v[88:91], v98 offset:6144
    ds_read_b128 v[92:95], v98 offset:6656
    s_mov_b64 exec, -1
    ds_read_b128 v[72:75], v97 offset:8192
    v_exp_f32 v26, v26
    v_exp_f32 v27, v27
    v_exp_f32 v28, v28
    v_exp_f32 v29, v29
    s_waitcnt lgkmcnt(3)
    v_mfma_f32_32x32x16_bf16 v[40:55], v[76:79], v[4:7], v[8:23]
    v_exp_f32 v30, v30
    v_exp_f32 v31, v31
    v_exp_f32 v32, v32
    v_exp_f32 v33, v33
    v_smfmac_f32_32x32x32_bf16 v[56:71], v[80:83], v[24:31], v96
    s_nop 0
    v_exp_f32 v34, v34
    v_exp_f32 v35, v35
    v_exp_f32 v36, v36
    v_exp_f32 v37, v37
    v_exp_f32 v38, v38
    v_exp_f32 v39, v39
    v_exp_f32 v40, v40
    v_exp_f32 v41, v41
    v_smfmac_f32_32x32x32_bf16 v[56:71], v[84:87], v[32:39], v96
    s_mov_b64 exec, s[32:33]
    ds_read_b128 v[80:83], v98 offset:8192
    ds_read_b128 v[84:87], v98 offset:8704
    s_mov_b64 exec, -1
    ds_read_b128 v[76:79], v97 offset:10240
    v_exp_f32 v42, v42
    v_exp_f32 v43, v43
    v_exp_f32 v44, v44
    v_exp_f32 v45, v45
    s_waitcnt lgkmcnt(3)
    v_mfma_f32_32x32x16_bf16 v[24:39], v[72:75], v[4:7], v[8:23]
    v_exp_f32 v46, v46
    v_exp_f32 v47, v47
    v_exp_f32 v48, v48
    v_exp_f32 v49, v49
    v_smfmac_f32_32x32x32_bf16 v[56:71], v[88:91], v[40:47], v96
    v_add_u32 v97, 8192, v97
    v_add_u32 v98, 8192, v98
    s_add_u32 s35, s35, 1
    s_add_u32 s38, s35, 3
    s_lshr_b32 s38, s38, 1
    s_min_u32 s38, s38, 8
    s_cmp_lt_u32 s35, 16
    v_exp_f32 v50, v50
    v_exp_f32 v51, v51
    v_exp_f32 v52, v52
    v_exp_f32 v53, v53
    v_exp_f32 v54, v54
    v_exp_f32 v55, v55
    s_cbranch_scc1 A_loop
    s_nop 1
    v_smfmac_f32_32x32x32_bf16 v[56:71], v[92:95], v[48:55], v96
    v_lshlrev_b32 v101, 4, v1
    s_lshl_b32 s23, s22, 15
    s_lshl_b32 s24, s21, 10
    s_add_u32 s23, s23, s24
    s_lshl_b32 s24, s3, 21
    s_add_u32 s23, s23, s24
    s_add_u32 s23, s23, 0x1200000
    s_mov_b32 s24, 0x21800000
    s_nop 7
    v_cmp_nle_f32 vcc, s24, v64
    v_rcp_f32 v102, v64
    s_cmp_eq_u32 s34, 0
    s_cbranch_scc0 A_store
    s_cbranch_vccnz A_redo
A_store:
    v_mul_f32 v56, v102, v56
    v_mul_f32 v57, v102, v57
    v_mul_f32 v58, v102, v58
    v_mul_f32 v59, v102, v59
    v_mul_f32 v60, v102, v60
    v_mul_f32 v61, v102, v61
    v_mul_f32 v62, v102, v62
    v_mul_f32 v63, v102, v63
    v_cvt_pk_bf16_f32 v104, v56, v57
    v_cvt_pk_bf16_f32 v105, v58, v59
    v_cvt_pk_bf16_f32 v106, v60, v61
    v_cvt_pk_bf16_f32 v107, v62, v63
    buffer_store_dwordx4 v[104:107], v101, s[16:19], s23 offen sc0 sc1
    s_load_dwordx2 s[4:5], s[0:1], 0
    s_load_dwordx2 s[40:41], s[0:1], 72
    v_lshlrev_b32 v2, 4, v1
    s_lshr_b32 s23, s22, 3
    s_lshl_b32 s24, s23, 3
    s_lshr_b32 s25, s21, 2
    s_add_u32 s24, s24, s25
    s_and_b32 s25, s21, 3
    s_lshl_b32 s33, s24, 15
    s_lshl_b32 s34, s25, 13
    s_add_u32 s34, s34, s33
    s_lshl_b32 s35, s20, 10
    s_add_u32 s34, s34, s35
    s_add_u32 s34, s34, 0x800000
    s_lshl_b32 s37, s20, 12
    s_add_u32 s38, s37, s33
    s_lshl_b32 s39, s3, 21
    s_add_u32 s38, s38, s39
    s_add_u32 s38, s38, 0x1200000
    v_add_u32 v6, s37, v2
    v_add_u32 v5, s35, v2
    v_and_b32 v7, 31, v1
    v_lshrrev_b32 v4, 5, v1
    v_lshlrev_b32 v8, 10, v7
    v_lshl_add_u32 v3, v4, 4, v8
    v_and_b32 v8, 0x13, v7
    v_lshrrev_b32 v9, 1, v7
    v_and_b32 v9, 4, v9
    v_or_b32 v8, v8, v9
    v_lshlrev_b32 v9, 1, v7
    v_and_b32 v9, 8, v9
    v_or_b32 v8, v8, v9
    v_lshlrev_b32 v8, 4, v8
    v_lshl_add_u32 v0, v4, 9, v8
    v_lshlrev_b32 v7, 3, v7
    s_mov_b32 s39, 0x40000
    s_cmp_ge_u32 s20, 4
    s_cbranch_scc1 F_poll
    s_lshl_b32 s27, s25, 2
    s_add_u32 s27, s27, s20
    s_lshl_b32 s31, s27, 15
    s_add_u32 s31, s31, 0xc00000
    s_lshl_b32 s36, s27, 6
    s_add_u32 s36, s36, s33
    s_lshl_b32 s30, s27, 11
    s_add_u32 s30, s30, s33
    s_add_u32 s30, s30, 0xa00000
    s_mov_b32 s10, 0x200000
    s_mov_b32 s11, 0x20000
    s_waitcnt lgkmcnt(0)
    s_mov_b32 s8, s4
    s_mov_b32 s9, s5
    s_cmp_eq_u32 s3, 0
    s_cbranch_scc0 F_x2
    buffer_load_dwordx4 v[160:163], v3, s[8:11], s36 offen
    buffer_load_dwordx4 v[164:167], v3, s[8:11], s36 offen offset:32
    s_branch F_x3
F_x2:
    buffer_load_dwordx4 v[160:163], v0, s[16:19], s30 offen sc0 sc1
    buffer_load_dwordx4 v[164:167], v0, s[16:19], s30 offen offset:1024 sc0 sc1
F_x3:
    s_cmp_eq_u32 s3, 1
    s_cbranch_scc1 F_w
    v_mov_b32 v8, 163800
    s_branch F_pk_1
F_pk:
    s_sleep 8
F_pk_1:
    ds_read_b32 v9, v8 offset:0
    s_waitcnt lgkmcnt(0)
    v_readfirstlane_b32 s44, v9
    s_nop 0
    s_cmp_lt_u32 s44, 1
    s_cbranch_scc1 F_pk
F_w:
    buffer_load_dwordx4 v[32:35], v2, s[16:19], s31 offen offset:0
    buffer_load_dwordx4 v[36:39], v2, s[16:19], s31 offen offset:1024
    buffer_load_dwordx4 v[40:43], v2, s[16:19], s31 offen offset:2048
    buffer_load_dwordx4 v[44:47], v2, s[16:19], s31 offen offset:3072
    s_add_u32 s31, s31, 4096
    buffer_load_dwordx4 v[48:51], v2, s[16:19], s31 offen offset:0
    buffer_load_dwordx4 v[52:55], v2, s[16:19], s31 offen offset:1024
    buffer_load_dwordx4 v[56:59], v2, s[16:19], s31 offen offset:2048
    buffer_load_dwordx4 v[60:63], v2, s[16:19], s31 offen offset:3072
    s_add_u32 s31, s31, 4096
    buffer_load_dwordx4 v[64:67], v2, s[16:19], s31 offen offset:0
    buffer_load_dwordx4 v[68:71], v2, s[16:19], s31 offen offset:1024
    buffer_load_dwordx4 v[72:75], v2, s[16:19], s31 offen offset:2048
    buffer_load_dwordx4 v[76:79], v2, s[16:19], s31 offen offset:3072
    s_add_u32 s31, s31, 4096
    buffer_load_dwordx4 v[80:83], v2, s[16:19], s31 offen offset:0
    buffer_load_dwordx4 v[84:87], v2, s[16:19], s31 offen offset:1024
    buffer_load_dwordx4 v[88:91], v2, s[16:19], s31 offen offset:2048
    buffer_load_dwordx4 v[92:95], v2, s[16:19], s31 offen offset:3072
    s_add_u32 s31, s31, 4096
    buffer_load_dwordx4 v[96:99], v2, s[16:19], s31 offen offset:0
    buffer_load_dwordx4 v[100:103], v2, s[16:19], s31 offen offset:1024
    buffer_load_dwordx4 v[104:107], v2, s[16:19], s31 offen offset:2048
    buffer_load_dwordx4 v[108:111], v2, s[16:19], s31 offen offset:3072
    s_add_u32 s31, s31, 4096
    buffer_load_dwordx4 v[112:115], v2, s[16:19], s31 offen offset:0
    buffer_load_dwordx4 v[116:119], v2, s[16:19], s31 offen offset:1024
    buffer_load_dwordx4 v[120:123], v2, s[16:19], s31 offen offset:2048
    buffer_load_dwordx4 v[124:127], v2, s[16:19], s31 offen offset:3072
    s_add_u32 s31, s31, 4096
    buffer_load_dwordx4 v[128:131], v2, s[16:19], s31 offen offset:0
    buffer_load_dwordx4 v[132:135], v2, s[16:19], s31 offen offset:1024
    buffer_load_dwordx4 v[136:139], v2, s[16:19], s31 offen offset:2048
    buffer_load_dwordx4 v[140:143], v2, s[16:19], s31 offen offset:3072
    s_add_u32 s31, s31, 4096
    buffer_load_dwordx4 v[144:147], v2, s[16:19], s31 offen offset:0
    buffer_load_dwordx4 v[148:151], v2, s[16:19], s31 offen offset:1024
    buffer_load_dwordx4 v[152:155], v2, s[16:19], s31 offen offset:2048
    buffer_load_dwordx4 v[156:159], v2, s[16:19], s31 offen offset:3072
    s_barrier
F_poll:
    buffer_load_dwordx4 v[8:11], v2, s[16:19], s38 offen offset:0 sc0 sc1
    buffer_load_dwordx4 v[12:15], v2, s[16:19], s38 offen offset:1024 sc0 sc1
    buffer_load_dwordx4 v[16:19], v2, s[16:19], s38 offen offset:2048 sc0 sc1
    buffer_load_dwordx4 v[20:23], v2, s[16:19], s38 offen offset:3072 sc0 sc1
    s_cmp_lt_u32 s20, 4
    s_cbranch_scc1 F_1
    s_cmp_eq_u32 s39, 0x40000
    s_cbranch_scc0 F_1
    s_barrier
F_1:
    buffer_load_dwordx4 v[24:27], v2, s[16:19], s34 offen
    s_waitcnt vmcnt(1)
    v_max3_u32 v28, v8, v9, v10
    v_max3_u32 v29, v11, v12, v13
    v_max3_u32 v30, v14, v15, v16
    v_max3_u32 v31, v17, v18, v19
    v_max3_u32 v28, v28, v20, v21
    v_max3_u32 v29, v29, v22, v23
    v_max3_u32 v28, v28, v29, v30
    v_max_u32 v28, v28, v31
    v_cmp_eq_u32 vcc, -1, v28
    s_sub_u32 s39, s39, 1
    s_cbranch_scc1 F_2
    s_cbranch_vccnz F_poll
F_2:
    ds_write_b128 v6, v[8:11] offset:0
    ds_write_b128 v6, v[12:15] offset:1024
    ds_write_b128 v6, v[16:19] offset:2048
    ds_write_b128 v6, v[20:23] offset:3072
    s_waitcnt vmcnt(0)
    ds_write_b128 v5, v[24:27] offset:32768
    s_waitcnt lgkmcnt(0)
    s_barrier
    s_cmp_ge_u32 s20, 4
    s_cbranch_scc1 F_k
    ds_read_b128 v[24:27], v2 offset:0
    ds_read_b128 v[28:31], v2 offset:1024
    v_bfe_u32 v6, v1, 2, 2
    v_lshl_add_u32 v6, v4, 3, v6
    v_lshlrev_b32 v6, 6, v6
    v_bfe_u32 v5, v1, 4, 1
    v_lshl_add_u32 v6, v5, 5, v6
    v_and_b32 v5, 3, v1
    v_lshl_add_u32 v6, v5, 3, v6
    s_lshl_b32 s37, s20, 11
    s_add_u32 s37, s37, 32768
    v_add_u32 v5, s37, v6
    s_waitcnt lgkmcnt(1)
    v_mfma_f32_32x32x16_bf16 v[8:23], v[32:35], v[24:27], 0
    ds_read_b128 v[32:35], v2 offset:2048
    ds_read_b128 v[24:27], v2 offset:3072
    s_waitcnt lgkmcnt(2)
    v_mfma_f32_32x32x16_bf16 v[8:23], v[36:39], v[28:31], v[8:23]
    ds_read_b128 v[36:39], v2 offset:4096
    ds_read_b128 v[28:31], v2 offset:5120
    s_waitcnt lgkmcnt(3)
    v_mfma_f32_32x32x16_bf16 v[8:23], v[40:43], v[32:35], v[8:23]
    ds_read_b128 v[40:43], v2 offset:6144
    ds_read_b128 v[32:35], v2 offset:7168
    s_waitcnt lgkmcnt(4)
    v_mfma_f32_32x32x16_bf16 v[8:23], v[44:47], v[24:27], v[8:23]
    ds_read_b128 v[44:47], v2 offset:8192
    ds_read_b128 v[24:27], v2 offset:9216
    s_waitcnt lgkmcnt(5)
    v_mfma_f32_32x32x16_bf16 v[8:23], v[48:51], v[36:39], v[8:23]
    ds_read_b128 v[48:51], v2 offset:10240
    ds_read_b128 v[36:39], v2 offset:11264
    s_waitcnt lgkmcnt(6)
    v_mfma_f32_32x32x16_bf16 v[8:23], v[52:55], v[28:31], v[8:23]
    ds_read_b128 v[52:55], v2 offset:12288
    ds_read_b128 v[28:31], v2 offset:13312
    s_waitcnt lgkmcnt(7)
    v_mfma_f32_32x32x16_bf16 v[8:23], v[56:59], v[40:43], v[8:23]
    ds_read_b128 v[56:59], v2 offset:14336
    s_waitcnt lgkmcnt(7)
    v_mfma_f32_32x32x16_bf16 v[8:23], v[60:63], v[32:35], v[8:23]
    ds_read_b128 v[40:43], v2 offset:15360
    s_waitcnt lgkmcnt(7)
    v_mfma_f32_32x32x16_bf16 v[8:23], v[64:67], v[44:47], v[8:23]
    ds_read_b128 v[60:63], v2 offset:16384
    s_waitcnt lgkmcnt(7)
    v_mfma_f32_32x32x16_bf16 v[8:23], v[68:71], v[24:27], v[8:23]
    ds_read_b128 v[32:35], v2 offset:17408
    s_waitcnt lgkmcnt(7)
    v_mfma_f32_32x32x16_bf16 v[8:23], v[72:75], v[48:51], v[8:23]
    ds_read_b128 v[64:67], v2 offset:18432
    s_waitcnt lgkmcnt(7)
    v_mfma_f32_32x32x16_bf16 v[8:23], v[76:79], v[36:39], v[8:23]
    ds_read_b128 v[44:47], v2 offset:19456
    s_waitcnt lgkmcnt(7)
    v_mfma_f32_32x32x16_bf16 v[8:23], v[80:83], v[52:55], v[8:23]
    ds_read_b128 v[68:71], v2 offset:20480
    s_waitcnt lgkmcnt(7)
    v_mfma_f32_32x32x16_bf16 v[8:23], v[84:87], v[28:31], v[8:23]
    ds_read_b128 v[24:27], v2 offset:21504
    s_waitcnt lgkmcnt(7)
    v_mfma_f32_32x32x16_bf16 v[8:23], v[88:91], v[56:59], v[8:23]
    ds_read_b128 v[72:75], v2 offset:22528
    s_waitcnt lgkmcnt(7)
    v_mfma_f32_32x32x16_bf16 v[8:23], v[92:95], v[40:43], v[8:23]
    ds_read_b128 v[48:51], v2 offset:23552
    s_waitcnt lgkmcnt(7)
    v_mfma_f32_32x32x16_bf16 v[8:23], v[96:99], v[60:63], v[8:23]
    ds_read_b128 v[76:79], v2 offset:24576
    s_waitcnt lgkmcnt(7)
    v_mfma_f32_32x32x16_bf16 v[8:23], v[100:103], v[32:35], v[8:23]
    ds_read_b128 v[36:39], v2 offset:25600
    s_waitcnt lgkmcnt(7)
    v_mfma_f32_32x32x16_bf16 v[8:23], v[104:107], v[64:67], v[8:23]
    ds_read_b128 v[80:83], v2 offset:26624
    s_waitcnt lgkmcnt(7)
    v_mfma_f32_32x32x16_bf16 v[8:23], v[108:111], v[44:47], v[8:23]
    ds_read_b128 v[52:55], v2 offset:27648
    s_waitcnt lgkmcnt(7)
    v_mfma_f32_32x32x16_bf16 v[8:23], v[112:115], v[68:71], v[8:23]
    ds_read_b128 v[84:87], v2 offset:28672
    s_waitcnt lgkmcnt(7)
    v_mfma_f32_32x32x16_bf16 v[8:23], v[116:119], v[24:27], v[8:23]
    ds_read_b128 v[28:31], v2 offset:29696
    s_waitcnt lgkmcnt(7)
    v_mfma_f32_32x32x16_bf16 v[8:23], v[120:123], v[72:75], v[8:23]
    ds_read_b128 v[88:91], v2 offset:30720
    s_waitcnt lgkmcnt(7)
    v_mfma_f32_32x32x16_bf16 v[8:23], v[124:127], v[48:51], v[8:23]
    ds_read_b128 v[56:59], v2 offset:31744
    s_waitcnt lgkmcnt(7)
    v_mfma_f32_32x32x16_bf16 v[8:23], v[128:131], v[76:79], v[8:23]
    s_waitcnt lgkmcnt(6)
    v_mfma_f32_32x32x16_bf16 v[8:23], v[132:135], v[36:39], v[8:23]
    s_waitcnt lgkmcnt(5)
    v_mfma_f32_32x32x16_bf16 v[8:23], v[136:139], v[80:83], v[8:23]
    s_waitcnt lgkmcnt(4)
    v_mfma_f32_32x32x16_bf16 v[8:23], v[140:143], v[52:55], v[8:23]
    s_waitcnt lgkmcnt(3)
    v_mfma_f32_32x32x16_bf16 v[8:23], v[144:147], v[84:87], v[8:23]
    s_waitcnt lgkmcnt(2)
    v_mfma_f32_32x32x16_bf16 v[8:23], v[148:151], v[28:31], v[8:23]
    s_waitcnt lgkmcnt(1)
    v_mfma_f32_32x32x16_bf16 v[8:23], v[152:155], v[88:91], v[8:23]
    s_waitcnt lgkmcnt(0)
    v_mfma_f32_32x32x16_bf16 v[8:23], v[156:159], v[56:59], v[8:23]
    ds_read_b64_tr_b16 v[24:25], v5 offset:0
    ds_read_b64_tr_b16 v[26:27], v5 offset:256
    ds_read_b64_tr_b16 v[28:29], v5 offset:1024
    ds_read_b64_tr_b16 v[30:31], v5 offset:1280
    s_mov_b32 s35, 0xffff0000
    v_lshlrev_b32 v32, 16, v160
    v_and_b32 v33, s35, v160
    v_lshlrev_b32 v34, 16, v161
    v_and_b32 v35, s35, v161
    v_lshlrev_b32 v36, 16, v162
    v_and_b32 v37, s35, v162
    v_lshlrev_b32 v38, 16, v163
    v_and_b32 v39, s35, v163
    v_lshlrev_b32 v40, 16, v164
    v_and_b32 v41, s35, v164
    v_lshlrev_b32 v42, 16, v165
    v_and_b32 v43, s35, v165
    v_lshlrev_b32 v44, 16, v166
    v_and_b32 v45, s35, v166
    v_lshlrev_b32 v46, 16, v167
    v_and_b32 v47, s35, v167
    s_lshl_b32 s37, s20, 8
    s_add_u32 s37, s37, 40960
    v_add_u32 v6, s37, v7
    s_lshl_b32 s33, s3, 18
    s_lshl_b32 s34, s24, 10
    s_add_u32 s33, s33, s34
    s_add_u32 s33, s33, 0xd00000
    s_lshl_b32 s34, s25, 8
    s_add_u32 s34, s34, s33
    v_pk_add_f32 v[32:33], v[32:33], v[8:9]
    v_cvt_pk_bf16_f32 v48, v32, v33
    v_lshlrev_b32 v32, 16, v48
    v_and_b32 v33, s35, v48
    v_pk_add_f32 v[34:35], v[34:35], v[10:11]
    v_cvt_pk_bf16_f32 v49, v34, v35
    v_lshlrev_b32 v34, 16, v49
    v_and_b32 v35, s35, v49
    v_pk_add_f32 v[36:37], v[36:37], v[12:13]
    v_cvt_pk_bf16_f32 v48, v36, v37
    v_lshlrev_b32 v36, 16, v48
    v_and_b32 v37, s35, v48
    v_pk_add_f32 v[38:39], v[38:39], v[14:15]
    v_cvt_pk_bf16_f32 v49, v38, v39
    v_lshlrev_b32 v38, 16, v49
    v_and_b32 v39, s35, v49
    v_pk_add_f32 v[40:41], v[40:41], v[16:17]
    v_cvt_pk_bf16_f32 v48, v40, v41
    v_lshlrev_b32 v40, 16, v48
    v_and_b32 v41, s35, v48
    v_pk_add_f32 v[42:43], v[42:43], v[18:19]
    v_cvt_pk_bf16_f32 v49, v42, v43
    v_lshlrev_b32 v42, 16, v49
    v_and_b32 v43, s35, v49
    v_pk_add_f32 v[44:45], v[44:45], v[20:21]
    v_cvt_pk_bf16_f32 v48, v44, v45
    v_lshlrev_b32 v44, 16, v48
    v_and_b32 v45, s35, v48
    v_pk_add_f32 v[46:47], v[46:47], v[22:23]
    v_cvt_pk_bf16_f32 v49, v46, v47
    v_lshlrev_b32 v46, 16, v49
    v_and_b32 v47, s35, v49
    v_pk_add_f32 v[50:51], v[32:33], v[34:35]
    v_pk_mul_f32 v[52:53], v[32:33], v[32:33]
    v_pk_fma_f32 v[52:53], v[34:35], v[34:35], v[52:53]
    v_pk_add_f32 v[50:51], v[50:51], v[36:37]
    v_pk_fma_f32 v[52:53], v[36:37], v[36:37], v[52:53]
    v_pk_add_f32 v[50:51], v[50:51], v[38:39]
    v_pk_fma_f32 v[52:53], v[38:39], v[38:39], v[52:53]
    v_pk_add_f32 v[50:51], v[50:51], v[40:41]
    v_pk_fma_f32 v[52:53], v[40:41], v[40:41], v[52:53]
    v_pk_add_f32 v[50:51], v[50:51], v[42:43]
    v_pk_fma_f32 v[52:53], v[42:43], v[42:43], v[52:53]
    v_pk_add_f32 v[50:51], v[50:51], v[44:45]
    v_pk_fma_f32 v[52:53], v[44:45], v[44:45], v[52:53]
    v_pk_add_f32 v[50:51], v[50:51], v[46:47]
    v_pk_fma_f32 v[52:53], v[46:47], v[46:47], v[52:53]
    v_add_f32 v50, v50, v51
    v_add_f32 v51, v52, v53
    v_mov_b32 v52, v50
    v_mov_b32 v53, v51
    s_nop 0
    v_permlane32_swap_b32 v50, v52
    v_permlane32_swap_b32 v51, v53
    v_pk_add_f32 v[50:51], v[50:51], v[52:53]
    ds_write_b64 v6, v[50:51]
    v_mov_b32 v6, 163808
    v_mov_b32 v9, 1
    s_mov_b64 exec, 1
    ds_add_u32 v6, v9
    s_mov_b64 exec, -1
    s_cmp_lg_u32 s20, 0
    s_cbranch_scc1 F_wait
    s_branch F_c_1
F_c:
    s_sleep 0
F_c_1:
    ds_read_b32 v8, v6 offset:0
    s_waitcnt lgkmcnt(0)
    v_readfirstlane_b32 s44, v8
    s_nop 0
    s_cmp_lt_u32 s44, 4
    s_cbranch_scc1 F_c
    ds_read_b64 v[72:73], v7 offset:40960
    ds_read_b64 v[74:75], v7 offset:41216
    ds_read_b64 v[76:77], v7 offset:41472
    ds_read_b64 v[78:79], v7 offset:41728
    s_mov_b32 s39, 0x40000
    s_waitcnt lgkmcnt(0)
    v_pk_add_f32 v[72:73], v[72:73], v[74:75]
    v_pk_add_f32 v[76:77], v[76:77], v[78:79]
    v_pk_add_f32 v[72:73], v[72:73], v[76:77]
    v_and_b32 v73, -2, v73
    s_mov_b32 exec_hi, 0
    buffer_store_dwordx2 v[72:73], v7, s[16:19], s34 offen sc0 sc1
    s_mov_b32 exec_hi, -1
F_xp:
    buffer_load_dwordx4 v[72:75], v2, s[16:19], s33 offen sc0 sc1
    s_waitcnt vmcnt(0)
    v_max_u32 v48, v73, v75
    v_cmp_eq_u32 vcc, -1, v48
    s_sub_u32 s39, s39, 1
    s_cbranch_scc1 F_got
    s_cbranch_vccnz F_xp
F_got:
    v_mov_b32 v76, v72
    v_mov_b32 v77, v73
    v_mov_b32 v78, v74
    v_mov_b32 v79, v75
    v_permlane32_swap_b32 v72, v76
    v_permlane32_swap_b32 v73, v77
    v_permlane32_swap_b32 v74, v78
    v_permlane32_swap_b32 v75, v79
    v_pk_add_f32 v[72:73], v[72:73], v[76:77]
    v_pk_add_f32 v[74:75], v[74:75], v[78:79]
    v_mov_b32 v76, v72
    v_mov_b32 v77, v73
    v_mov_b32 v78, v74
    v_mov_b32 v79, v75
    v_permlane16_swap_b32 v72, v76
    v_permlane16_swap_b32 v73, v77
    v_permlane16_swap_b32 v74, v78
    v_permlane16_swap_b32 v75, v79
    v_pk_add_f32 v[72:73], v[72:73], v[76:77]
    v_pk_add_f32 v[74:75], v[74:75], v[78:79]
    ds_write_b128 v2, v[72:75] offset:41984
    ds_write_b32 v6, v9 offset:4
F_wait:
    s_waitcnt lgkmcnt(0)
    v_lshlrev_b32 v56, 16, v24
    v_and_b32 v57, s35, v24
    v_lshlrev_b32 v58, 16, v25
    v_and_b32 v59, s35, v25
    v_lshlrev_b32 v60, 16, v26
    v_and_b32 v61, s35, v26
    v_lshlrev_b32 v62, 16, v27
    v_and_b32 v63, s35, v27
    v_lshlrev_b32 v64, 16, v28
    v_and_b32 v65, s35, v28
    v_lshlrev_b32 v66, 16, v29
    v_and_b32 v67, s35, v29
    v_lshlrev_b32 v68, 16, v30
    v_and_b32 v69, s35, v30
    v_lshlrev_b32 v70, 16, v31
    v_and_b32 v71, s35, v31
    s_branch F_d_1
F_d:
    s_sleep 1
F_d_1:
    ds_read_b32 v8, v6 offset:4
    s_waitcnt lgkmcnt(0)
    v_readfirstlane_b32 s44, v8
    s_nop 0
    s_cmp_lt_u32 s44, 1
    s_cbranch_scc1 F_d
    ds_read_b64 v[50:51], v7 offset:41984
    s_waitcnt lgkmcnt(0)
    v_mul_f32 v50, 0x3b000000, v50
    v_mul_f32 v51, 0x3b000000, v51
    v_fma_f32 v51, -v50, v50, v51
    v_max_f32 v51, 0, v51
    v_cvt_pk_bf16_f32 v48, v50, v51
    v_lshlrev_b32 v50, 16, v48
    v_and_b32 v52, s35, v48
    v_add_f32 v52, 0x3727c5ac, v52
    v_cvt_pk_bf16_f32 v48, v52, v52
    v_lshlrev_b32 v52, 16, v48
    v_sqrt_f32 v52, v52
    v_sub_f32 v50, 0, v50
    v_cvt_pk_bf16_f32 v48, v52, v52
    v_lshlrev_b32 v52, 16, v48
    v_rcp_f32 v52, v52
    v_mov_b32 v51, v50
    v_mov_b32 v53, v52
    s_cmp_eq_u32 s3, 0
    s_mov_b32 s12, s40
    s_mov_b32 s13, s41
    s_mov_b32 s14, 0x200000
    s_mov_b32 s15, 0x20000
    v_pk_add_f32 v[8:9], v[32:33], v[50:51]
    v_pk_mul_f32 v[8:9], v[8:9], v[52:53]
    v_pk_fma_f32 v[8:9], v[8:9], v[56:57], v[32:33]
    v_cvt_pk_bf16_f32 v80, v8, v9
    v_pk_add_f32 v[10:11], v[34:35], v[50:51]
    v_pk_mul_f32 v[10:11], v[10:11], v[52:53]
    v_pk_fma_f32 v[10:11], v[10:11], v[58:59], v[34:35]
    v_cvt_pk_bf16_f32 v81, v10, v11
    v_pk_add_f32 v[12:13], v[36:37], v[50:51]
    v_pk_mul_f32 v[12:13], v[12:13], v[52:53]
    v_pk_fma_f32 v[12:13], v[12:13], v[60:61], v[36:37]
    v_cvt_pk_bf16_f32 v82, v12, v13
    v_pk_add_f32 v[14:15], v[38:39], v[50:51]
    v_pk_mul_f32 v[14:15], v[14:15], v[52:53]
    v_pk_fma_f32 v[14:15], v[14:15], v[62:63], v[38:39]
    v_cvt_pk_bf16_f32 v83, v14, v15
    v_pk_add_f32 v[16:17], v[40:41], v[50:51]
    v_pk_mul_f32 v[16:17], v[16:17], v[52:53]
    v_pk_fma_f32 v[16:17], v[16:17], v[64:65], v[40:41]
    v_cvt_pk_bf16_f32 v84, v16, v17
    v_pk_add_f32 v[18:19], v[42:43], v[50:51]
    v_pk_mul_f32 v[18:19], v[18:19], v[52:53]
    v_pk_fma_f32 v[18:19], v[18:19], v[66:67], v[42:43]
    v_cvt_pk_bf16_f32 v85, v18, v19
    v_pk_add_f32 v[20:21], v[44:45], v[50:51]
    v_pk_mul_f32 v[20:21], v[20:21], v[52:53]
    v_pk_fma_f32 v[20:21], v[20:21], v[68:69], v[44:45]
    v_cvt_pk_bf16_f32 v86, v20, v21
    v_pk_add_f32 v[22:23], v[46:47], v[50:51]
    v_pk_mul_f32 v[22:23], v[22:23], v[52:53]
    v_pk_fma_f32 v[22:23], v[22:23], v[70:71], v[46:47]
    v_cvt_pk_bf16_f32 v87, v22, v23
    s_cbranch_scc0 F_out
    buffer_store_dwordx4 v[80:83], v0, s[16:19], s30 offen sc1
    buffer_store_dwordx4 v[84:87], v0, s[16:19], s30 offen offset:1024 sc1
    v_mov_b32 v9, 1
    v_mov_b32 v8, 0
    s_lshl_b32 s30, s24, 9
    s_lshl_b32 s31, s25, 7
    s_add_u32 s30, s30, s31
    s_add_u32 s30, s30, 0xd19000
    s_mov_b64 exec, 1
    s_waitcnt vmcnt(0)
    ds_add_rtn_u32 v10, v6, v9
    s_waitcnt lgkmcnt(0)
    v_readfirstlane_b32 s44, v10
    s_nop 0
    s_cmp_lg_u32 s44, 7
    s_cbranch_scc1 F_nf
    buffer_store_dword v9, v8, s[16:19], s30 offen sc0 sc1
F_nf:
    s_mov_b64 exec, -1
    s_branch F_next
F_k:
    s_cmp_eq_u32 s3, 1
    s_cbranch_scc1 F_end
    s_and_b32 s21, s20, 1
    s_bfe_u32 s22, s20, 0x10001
    s_and_b32 s26, s20, 3
    s_and_b32 s30, s2, 7
    s_lshr_b32 s31, s2, 3
    s_and_b32 s23, s30, 3
    s_lshl_b32 s23, s23, 3
    s_and_b32 s32, s31, 7
    s_add_u32 s23, s23, s32
    s_lshr_b32 s24, s30, 2
    s_lshl_b32 s24, s24, 2
    s_lshr_b32 s31, s31, 3
    s_add_u32 s24, s24, s31
    v_lshlrev_b32 v2, 4, v1
    s_lshl_b32 s30, s24, 1
    s_add_u32 s30, s30, s21
    s_lshl_b32 s33, s30, 1
    s_add_u32 s33, s33, s22
    s_mul_i32 s33, s33, 49152
    s_add_u32 s33, s33, 0x1080000
    buffer_load_dwordx4 v[16:19], v2, s[16:19], s33 offen offset:0
    buffer_load_dwordx4 v[20:23], v2, s[16:19], s33 offen offset:1024
    buffer_load_dwordx4 v[24:27], v2, s[16:19], s33 offen offset:2048
    s_add_u32 s33, s33, 3072
    buffer_load_dwordx4 v[28:31], v2, s[16:19], s33 offen offset:0
    buffer_load_dwordx4 v[32:35], v2, s[16:19], s33 offen offset:1024
    buffer_load_dwordx4 v[36:39], v2, s[16:19], s33 offen offset:2048
    s_add_u32 s33, s33, 3072
    buffer_load_dwordx4 v[40:43], v2, s[16:19], s33 offen offset:0
    buffer_load_dwordx4 v[44:47], v2, s[16:19], s33 offen offset:1024
    buffer_load_dwordx4 v[48:51], v2, s[16:19], s33 offen offset:2048
    s_add_u32 s33, s33, 3072
    buffer_load_dwordx4 v[52:55], v2, s[16:19], s33 offen offset:0
    buffer_load_dwordx4 v[56:59], v2, s[16:19], s33 offen offset:1024
    buffer_load_dwordx4 v[60:63], v2, s[16:19], s33 offen offset:2048
    s_add_u32 s33, s33, 3072
    v_and_b32 v14, 31, v1
    v_lshrrev_b32 v13, 5, v1
    s_mul_i32 s41, s22, 49152
    s_add_u32 s41, s41, 45056
    v_add_u32 v3, s41, v2
    s_lshl_b32 s41, s22, 14
    s_sub_u32 s41, 77824, s41
    v_add_u32 v4, s41, v2
    v_mov_b32 v11, 163808
    v_and_b32 v64, 0x13, v14
    v_lshrrev_b32 v65, 1, v14
    v_and_b32 v65, 4, v65
    v_or_b32 v64, v64, v65
    v_lshlrev_b32 v65, 1, v14
    v_and_b32 v65, 8, v65
    v_or_b32 v12, v64, v65
    s_lshl_b32 s41, s22, 3
    s_add_u32 s41, s41, 163776
    v_mov_b32 v5, s41
    s_branch H_x0_1
H_x0:
    s_sleep 1
H_x0_1:
    ds_read_b64 v[6:7], v5
    s_waitcnt lgkmcnt(0)
    v_min_u32 v6, v6, v7
    s_nop 0
    v_readfirstlane_b32 s44, v6
    s_nop 0
    s_cmp_le_u32 s44, 0
    s_cbranch_scc1 H_x0
    ds_read_b128 v[160:163], v3 offset:0
    ds_read_b128 v[164:167], v4 offset:0
    s_waitcnt vmcnt(9) lgkmcnt(1)
    v_mfma_f32_32x32x16_bf16 v[64:79], v[16:19], v[160:163], 0
    v_mfma_f32_32x32x16_bf16 v[80:95], v[20:23], v[160:163], 0
    v_mfma_f32_32x32x16_bf16 v[96:111], v[160:163], v[24:27], 0
    ds_read_b128 v[160:163], v3 offset:1024
    s_waitcnt lgkmcnt(1)
    v_mfma_f32_32x32x16_bf16 v[112:127], v[16:19], v[164:167], 0
    buffer_load_dwordx4 v[16:19], v2, s[16:19], s33 offen offset:0
    v_mfma_f32_32x32x16_bf16 v[128:143], v[20:23], v[164:167], 0
    buffer_load_dwordx4 v[20:23], v2, s[16:19], s33 offen offset:1024
    v_mfma_f32_32x32x16_bf16 v[144:159], v[164:167], v[24:27], 0
    buffer_load_dwordx4 v[24:27], v2, s[16:19], s33 offen offset:2048
    ds_read_b128 v[164:167], v4 offset:1024
    s_add_u32 s33, s33, 3072
    s_waitcnt vmcnt(9) lgkmcnt(1)
    v_mfma_f32_32x32x16_bf16 v[64:79], v[28:31], v[160:163], v[64:79]
    v_mfma_f32_32x32x16_bf16 v[80:95], v[32:35], v[160:163], v[80:95]
    v_mfma_f32_32x32x16_bf16 v[96:111], v[160:163], v[36:39], v[96:111]
    ds_read_b128 v[160:163], v3 offset:2048
    s_waitcnt lgkmcnt(1)
    v_mfma_f32_32x32x16_bf16 v[112:127], v[28:31], v[164:167], v[112:127]
    buffer_load_dwordx4 v[28:31], v2, s[16:19], s33 offen offset:0
    v_mfma_f32_32x32x16_bf16 v[128:143], v[32:35], v[164:167], v[128:143]
    buffer_load_dwordx4 v[32:35], v2, s[16:19], s33 offen offset:1024
    v_mfma_f32_32x32x16_bf16 v[144:159], v[164:167], v[36:39], v[144:159]
    buffer_load_dwordx4 v[36:39], v2, s[16:19], s33 offen offset:2048
    ds_read_b128 v[164:167], v4 offset:2048
    s_add_u32 s33, s33, 3072
    s_waitcnt vmcnt(9) lgkmcnt(1)
    v_mfma_f32_32x32x16_bf16 v[64:79], v[40:43], v[160:163], v[64:79]
    v_mfma_f32_32x32x16_bf16 v[80:95], v[44:47], v[160:163], v[80:95]
    v_mfma_f32_32x32x16_bf16 v[96:111], v[160:163], v[48:51], v[96:111]
    ds_read_b128 v[160:163], v3 offset:3072
    s_waitcnt lgkmcnt(1)
    v_mfma_f32_32x32x16_bf16 v[112:127], v[40:43], v[164:167], v[112:127]
    buffer_load_dwordx4 v[40:43], v2, s[16:19], s33 offen offset:0
    v_mfma_f32_32x32x16_bf16 v[128:143], v[44:47], v[164:167], v[128:143]
    buffer_load_dwordx4 v[44:47], v2, s[16:19], s33 offen offset:1024
    v_mfma_f32_32x32x16_bf16 v[144:159], v[164:167], v[48:51], v[144:159]
    buffer_load_dwordx4 v[48:51], v2, s[16:19], s33 offen offset:2048
    ds_read_b128 v[164:167], v4 offset:3072
    s_add_u32 s33, s33, 3072
    s_waitcnt vmcnt(9) lgkmcnt(1)
    v_mfma_f32_32x32x16_bf16 v[64:79], v[52:55], v[160:163], v[64:79]
    v_mfma_f32_32x32x16_bf16 v[80:95], v[56:59], v[160:163], v[80:95]
    v_mfma_f32_32x32x16_bf16 v[96:111], v[160:163], v[60:63], v[96:111]
    s_cmp_gt_u32 s44, 1
    s_cbranch_scc1 H_y3
    s_branch H_x1_1
H_x1:
    s_sleep 1
H_x1_1:
    ds_read_b64 v[6:7], v5
    s_waitcnt lgkmcnt(0)
    v_min_u32 v6, v6, v7
    s_nop 0
    v_readfirstlane_b32 s44, v6
    s_nop 0
    s_cmp_le_u32 s44, 1
    s_cbranch_scc1 H_x1
H_y3:
    ds_read_b128 v[160:163], v3 offset:4096
    s_waitcnt lgkmcnt(1)
    v_mfma_f32_32x32x16_bf16 v[112:127], v[52:55], v[164:167], v[112:127]
    buffer_load_dwordx4 v[52:55], v2, s[16:19], s33 offen offset:0
    v_mfma_f32_32x32x16_bf16 v[128:143], v[56:59], v[164:167], v[128:143]
    buffer_load_dwordx4 v[56:59], v2, s[16:19], s33 offen offset:1024
    v_mfma_f32_32x32x16_bf16 v[144:159], v[164:167], v[60:63], v[144:159]
    buffer_load_dwordx4 v[60:63], v2, s[16:19], s33 offen offset:2048
    ds_read_b128 v[164:167], v4 offset:4096
    s_add_u32 s33, s33, 3072
    s_waitcnt vmcnt(9) lgkmcnt(1)
    v_mfma_f32_32x32x16_bf16 v[64:79], v[16:19], v[160:163], v[64:79]
    v_mfma_f32_32x32x16_bf16 v[80:95], v[20:23], v[160:163], v[80:95]
    v_mfma_f32_32x32x16_bf16 v[96:111], v[160:163], v[24:27], v[96:111]
    ds_read_b128 v[160:163], v3 offset:5120
    s_waitcnt lgkmcnt(1)
    v_mfma_f32_32x32x16_bf16 v[112:127], v[16:19], v[164:167], v[112:127]
    buffer_load_dwordx4 v[16:19], v2, s[16:19], s33 offen offset:0
    v_mfma_f32_32x32x16_bf16 v[128:143], v[20:23], v[164:167], v[128:143]
    buffer_load_dwordx4 v[20:23], v2, s[16:19], s33 offen offset:1024
    v_mfma_f32_32x32x16_bf16 v[144:159], v[164:167], v[24:27], v[144:159]
    buffer_load_dwordx4 v[24:27], v2, s[16:19], s33 offen offset:2048
    ds_read_b128 v[164:167], v4 offset:5120
    s_add_u32 s33, s33, 3072
    s_waitcnt vmcnt(9) lgkmcnt(1)
    v_mfma_f32_32x32x16_bf16 v[64:79], v[28:31], v[160:163], v[64:79]
    v_mfma_f32_32x32x16_bf16 v[80:95], v[32:35], v[160:163], v[80:95]
    v_mfma_f32_32x32x16_bf16 v[96:111], v[160:163], v[36:39], v[96:111]
    ds_read_b128 v[160:163], v3 offset:6144
    s_waitcnt lgkmcnt(1)
    v_mfma_f32_32x32x16_bf16 v[112:127], v[28:31], v[164:167], v[112:127]
    buffer_load_dwordx4 v[28:31], v2, s[16:19], s33 offen offset:0
    v_mfma_f32_32x32x16_bf16 v[128:143], v[32:35], v[164:167], v[128:143]
    buffer_load_dwordx4 v[32:35], v2, s[16:19], s33 offen offset:1024
    v_mfma_f32_32x32x16_bf16 v[144:159], v[164:167], v[36:39], v[144:159]
    buffer_load_dwordx4 v[36:39], v2, s[16:19], s33 offen offset:2048
    ds_read_b128 v[164:167], v4 offset:6144
    s_add_u32 s33, s33, 3072
    s_waitcnt vmcnt(9) lgkmcnt(1)
    v_mfma_f32_32x32x16_bf16 v[64:79], v[40:43], v[160:163], v[64:79]
    v_mfma_f32_32x32x16_bf16 v[80:95], v[44:47], v[160:163], v[80:95]
    v_mfma_f32_32x32x16_bf16 v[96:111], v[160:163], v[48:51], v[96:111]
    ds_read_b128 v[160:163], v3 offset:7168
    s_waitcnt lgkmcnt(1)
    v_mfma_f32_32x32x16_bf16 v[112:127], v[40:43], v[164:167], v[112:127]
    buffer_load_dwordx4 v[40:43], v2, s[16:19], s33 offen offset:0
    v_mfma_f32_32x32x16_bf16 v[128:143], v[44:47], v[164:167], v[128:143]
    buffer_load_dwordx4 v[44:47], v2, s[16:19], s33 offen offset:1024
    v_mfma_f32_32x32x16_bf16 v[144:159], v[164:167], v[48:51], v[144:159]
    buffer_load_dwordx4 v[48:51], v2, s[16:19], s33 offen offset:2048
    ds_read_b128 v[164:167], v4 offset:7168
    s_add_u32 s33, s33, 3072
    s_waitcnt vmcnt(9) lgkmcnt(1)
    v_mfma_f32_32x32x16_bf16 v[64:79], v[52:55], v[160:163], v[64:79]
    v_mfma_f32_32x32x16_bf16 v[80:95], v[56:59], v[160:163], v[80:95]
    v_mfma_f32_32x32x16_bf16 v[96:111], v[160:163], v[60:63], v[96:111]
    s_cmp_gt_u32 s44, 2
    s_cbranch_scc1 H_y7
    s_branch H_x2_1
H_x2:
    s_sleep 1
H_x2_1:
    ds_read_b64 v[6:7], v5
    s_waitcnt lgkmcnt(0)
    v_min_u32 v6, v6, v7
    s_nop 0
    v_readfirstlane_b32 s44, v6
    s_nop 0
    s_cmp_le_u32 s44, 2
    s_cbranch_scc1 H_x2
H_y7:
    ds_read_b128 v[160:163], v3 offset:8192
    s_waitcnt lgkmcnt(1)
    v_mfma_f32_32x32x16_bf16 v[112:127], v[52:55], v[164:167], v[112:127]
    buffer_load_dwordx4 v[52:55], v2, s[16:19], s33 offen offset:0
    v_mfma_f32_32x32x16_bf16 v[128:143], v[56:59], v[164:167], v[128:143]
    buffer_load_dwordx4 v[56:59], v2, s[16:19], s33 offen offset:1024
    v_mfma_f32_32x32x16_bf16 v[144:159], v[164:167], v[60:63], v[144:159]
    buffer_load_dwordx4 v[60:63], v2, s[16:19], s33 offen offset:2048
    ds_read_b128 v[164:167], v4 offset:8192
    s_add_u32 s33, s33, 3072
    s_waitcnt vmcnt(9) lgkmcnt(1)
    v_mfma_f32_32x32x16_bf16 v[64:79], v[16:19], v[160:163], v[64:79]
    v_mfma_f32_32x32x16_bf16 v[80:95], v[20:23], v[160:163], v[80:95]
    v_mfma_f32_32x32x16_bf16 v[96:111], v[160:163], v[24:27], v[96:111]
    ds_read_b128 v[160:163], v3 offset:9216
    s_waitcnt lgkmcnt(1)
    v_mfma_f32_32x32x16_bf16 v[112:127], v[16:19], v[164:167], v[112:127]
    buffer_load_dwordx4 v[16:19], v2, s[16:19], s33 offen offset:0
    v_mfma_f32_32x32x16_bf16 v[128:143], v[20:23], v[164:167], v[128:143]
    buffer_load_dwordx4 v[20:23], v2, s[16:19], s33 offen offset:1024
    v_mfma_f32_32x32x16_bf16 v[144:159], v[164:167], v[24:27], v[144:159]
    buffer_load_dwordx4 v[24:27], v2, s[16:19], s33 offen offset:2048
    ds_read_b128 v[164:167], v4 offset:9216
    s_add_u32 s33, s33, 3072
    s_waitcnt vmcnt(9) lgkmcnt(1)
    v_mfma_f32_32x32x16_bf16 v[64:79], v[28:31], v[160:163], v[64:79]
    v_mfma_f32_32x32x16_bf16 v[80:95], v[32:35], v[160:163], v[80:95]
    v_mfma_f32_32x32x16_bf16 v[96:111], v[160:163], v[36:39], v[96:111]
    ds_read_b128 v[160:163], v3 offset:10240
    s_waitcnt lgkmcnt(1)
    v_mfma_f32_32x32x16_bf16 v[112:127], v[28:31], v[164:167], v[112:127]
    buffer_load_dwordx4 v[28:31], v2, s[16:19], s33 offen offset:0
    v_mfma_f32_32x32x16_bf16 v[128:143], v[32:35], v[164:167], v[128:143]
    buffer_load_dwordx4 v[32:35], v2, s[16:19], s33 offen offset:1024
    v_mfma_f32_32x32x16_bf16 v[144:159], v[164:167], v[36:39], v[144:159]
    buffer_load_dwordx4 v[36:39], v2, s[16:19], s33 offen offset:2048
    ds_read_b128 v[164:167], v4 offset:10240
    s_add_u32 s33, s33, 3072
    s_waitcnt vmcnt(9) lgkmcnt(1)
    v_mfma_f32_32x32x16_bf16 v[64:79], v[40:43], v[160:163], v[64:79]
    v_mfma_f32_32x32x16_bf16 v[80:95], v[44:47], v[160:163], v[80:95]
    v_mfma_f32_32x32x16_bf16 v[96:111], v[160:163], v[48:51], v[96:111]
    ds_read_b128 v[160:163], v3 offset:11264
    s_waitcnt lgkmcnt(1)
    v_mfma_f32_32x32x16_bf16 v[112:127], v[40:43], v[164:167], v[112:127]
    buffer_load_dwordx4 v[40:43], v2, s[16:19], s33 offen offset:0
    v_mfma_f32_32x32x16_bf16 v[128:143], v[44:47], v[164:167], v[128:143]
    buffer_load_dwordx4 v[44:47], v2, s[16:19], s33 offen offset:1024
    v_mfma_f32_32x32x16_bf16 v[144:159], v[164:167], v[48:51], v[144:159]
    buffer_load_dwordx4 v[48:51], v2, s[16:19], s33 offen offset:2048
    ds_read_b128 v[164:167], v4 offset:11264
    s_add_u32 s33, s33, 3072
    s_waitcnt vmcnt(9) lgkmcnt(1)
    v_mfma_f32_32x32x16_bf16 v[64:79], v[52:55], v[160:163], v[64:79]
    v_mfma_f32_32x32x16_bf16 v[80:95], v[56:59], v[160:163], v[80:95]
    v_mfma_f32_32x32x16_bf16 v[96:111], v[160:163], v[60:63], v[96:111]
    s_cmp_gt_u32 s44, 3
    s_cbranch_scc1 H_y11
    s_branch H_x3_1
H_x3:
    s_sleep 1
H_x3_1:
    ds_read_b64 v[6:7], v5
    s_waitcnt lgkmcnt(0)
    v_min_u32 v6, v6, v7
    s_nop 0
    v_readfirstlane_b32 s44, v6
    s_nop 0
    s_cmp_le_u32 s44, 3
    s_cbranch_scc1 H_x3
H_y11:
    ds_read_b128 v[160:163], v3 offset:12288
    s_waitcnt lgkmcnt(1)
    v_mfma_f32_32x32x16_bf16 v[112:127], v[52:55], v[164:167], v[112:127]
    buffer_load_dwordx4 v[52:55], v2, s[16:19], s33 offen offset:0
    v_mfma_f32_32x32x16_bf16 v[128:143], v[56:59], v[164:167], v[128:143]
    buffer_load_dwordx4 v[56:59], v2, s[16:19], s33 offen offset:1024
    v_mfma_f32_32x32x16_bf16 v[144:159], v[164:167], v[60:63], v[144:159]
    buffer_load_dwordx4 v[60:63], v2, s[16:19], s33 offen offset:2048
    ds_read_b128 v[164:167], v4 offset:12288
    s_add_u32 s33, s33, 3072
    s_waitcnt vmcnt(9) lgkmcnt(1)
    v_mfma_f32_32x32x16_bf16 v[64:79], v[16:19], v[160:163], v[64:79]
    v_mfma_f32_32x32x16_bf16 v[80:95], v[20:23], v[160:163], v[80:95]
    v_mfma_f32_32x32x16_bf16 v[96:111], v[160:163], v[24:27], v[96:111]
    ds_read_b128 v[160:163], v3 offset:13312
    s_waitcnt lgkmcnt(1)
    v_mfma_f32_32x32x16_bf16 v[112:127], v[16:19], v[164:167], v[112:127]
    v_mfma_f32_32x32x16_bf16 v[128:143], v[20:23], v[164:167], v[128:143]
    v_mfma_f32_32x32x16_bf16 v[144:159], v[164:167], v[24:27], v[144:159]
    ds_read_b128 v[164:167], v4 offset:13312
    s_waitcnt vmcnt(6) lgkmcnt(1)
    v_mfma_f32_32x32x16_bf16 v[64:79], v[28:31], v[160:163], v[64:79]
    v_mfma_f32_32x32x16_bf16 v[80:95], v[32:35], v[160:163], v[80:95]
    v_mfma_f32_32x32x16_bf16 v[96:111], v[160:163], v[36:39], v[96:111]
    ds_read_b128 v[160:163], v3 offset:14336
    s_waitcnt lgkmcnt(1)
    v_mfma_f32_32x32x16_bf16 v[112:127], v[28:31], v[164:167], v[112:127]
    v_mfma_f32_32x32x16_bf16 v[128:143], v[32:35], v[164:167], v[128:143]
    v_mfma_f32_32x32x16_bf16 v[144:159], v[164:167], v[36:39], v[144:159]
    ds_read_b128 v[164:167], v4 offset:14336
    s_waitcnt vmcnt(3) lgkmcnt(1)
    v_mfma_f32_32x32x16_bf16 v[64:79], v[40:43], v[160:163], v[64:79]
    v_mfma_f32_32x32x16_bf16 v[80:95], v[44:47], v[160:163], v[80:95]
    v_mfma_f32_32x32x16_bf16 v[96:111], v[160:163], v[48:51], v[96:111]
    ds_read_b128 v[160:163], v3 offset:15360
    s_waitcnt lgkmcnt(1)
    v_mfma_f32_32x32x16_bf16 v[112:127], v[40:43], v[164:167], v[112:127]
    v_mfma_f32_32x32x16_bf16 v[128:143], v[44:47], v[164:167], v[128:143]
    v_mfma_f32_32x32x16_bf16 v[144:159], v[164:167], v[48:51], v[144:159]
    ds_read_b128 v[164:167], v4 offset:15360
    s_waitcnt vmcnt(0) lgkmcnt(1)
    v_mfma_f32_32x32x16_bf16 v[64:79], v[52:55], v[160:163], v[64:79]
    v_mfma_f32_32x32x16_bf16 v[80:95], v[56:59], v[160:163], v[80:95]
    v_mfma_f32_32x32x16_bf16 v[96:111], v[160:163], v[60:63], v[96:111]
    s_waitcnt lgkmcnt(0)
    v_mfma_f32_32x32x16_bf16 v[112:127], v[52:55], v[164:167], v[112:127]
    v_mfma_f32_32x32x16_bf16 v[128:143], v[56:59], v[164:167], v[128:143]
    v_mfma_f32_32x32x16_bf16 v[144:159], v[164:167], v[60:63], v[144:159]
    s_mul_i32 s44, s26, 12288
    s_add_u32 s44, s44, 110592
    v_add_u32 v40, s44, v2
    s_xor_b32 s45, s26, 2
    s_mul_i32 s45, s45, 12288
    s_add_u32 s45, s45, 110592
    v_add_u32 v41, s45, v2
    s_mul_i32 s44, s30, 384
    s_add_u32 s44, s44, 0xc90000
    v_lshlrev_b32 v42, 2, v14
    buffer_load_dword v44, v42, s[16:19], s44 offen offset:0
    buffer_load_dword v45, v42, s[16:19], s44 offen offset:128
    buffer_load_dword v46, v42, s[16:19], s44 offen offset:256
    s_lshl_b32 s44, s21, 2
    s_add_u32 s44, s44, 163824
    v_mov_b32 v15, s44
    v_mov_b32 v43, 1
    ds_write_b128 v40, v[112:115] offset:0
    ds_write_b128 v40, v[116:119] offset:1024
    ds_write_b128 v40, v[120:123] offset:2048
    ds_write_b128 v40, v[124:127] offset:3072
    ds_write_b128 v40, v[128:131] offset:4096
    ds_write_b128 v40, v[132:135] offset:5120
    ds_write_b128 v40, v[136:139] offset:6144
    ds_write_b128 v40, v[140:143] offset:7168
    ds_write_b128 v40, v[144:147] offset:8192
    ds_write_b128 v40, v[148:151] offset:9216
    ds_write_b128 v40, v[152:155] offset:10240
    ds_write_b128 v40, v[156:159] offset:11264
    s_mov_b64 exec, 1
    ds_add_u32 v15, v43
    s_mov_b64 exec, -1
    s_lshl_b32 s41, s22, 8
    s_add_u32 s41, s41, 159744
    v_lshl_add_u32 v40, v14, 3, s41
    s_lshl_b32 s43, s24, 2
    s_lshl_b32 s44, s21, 1
    s_add_u32 s43, s43, s44
    s_lshl_b32 s42, s23, 1
    s_add_u32 s42, s42, s22
    s_lshl_b32 s30, s43, 16
    s_lshl_b32 s31, s42, 10
    s_add_u32 s30, s30, s31
    s_lshl_b32 s32, s30, 1
    s_add_u32 s30, s30, 0x1600000
    s_add_u32 s31, s30, 65536
    s_add_u32 s32, s32, 0x1800000
    s_add_u32 s33, s32, 131072
H_es:
    ds_read_b32 v48, v11 offset:12
    ds_read_b32 v49, v15
    ds_read_b64 v[54:55], v40
    ds_read_b64 v[56:57], v40 offset:512
    s_waitcnt lgkmcnt(0)
    v_readfirstlane_b32 s44, v48
    v_readfirstlane_b32 s45, v49
    s_cmp_lt_u32 s44, 4
    s_cbranch_scc1 H_es
    s_cmp_lt_u32 s45, 2
    s_cbranch_scc1 H_es
    ds_read_b128 v[112:115], v41 offset:0
    ds_read_b128 v[116:119], v41 offset:1024
    ds_read_b128 v[120:123], v41 offset:2048
    ds_read_b128 v[124:127], v41 offset:3072
    ds_read_b128 v[128:131], v41 offset:4096
    ds_read_b128 v[132:135], v41 offset:5120
    ds_read_b128 v[136:139], v41 offset:6144
    ds_read_b128 v[140:143], v41 offset:7168
    ds_read_b128 v[144:147], v41 offset:8192
    ds_read_b128 v[148:151], v41 offset:9216
    ds_read_b128 v[152:155], v41 offset:10240
    ds_read_b128 v[156:159], v41 offset:11264
    v_cmp_eq_u32 vcc, 0, v13
    s_waitcnt vmcnt(0)
    s_nop 0
    v_cndmask_b32 v44, 0, v44, vcc
    v_cvt_pk_bf16_f32 v60, v44, v44
    v_lshlrev_b32 v60, 16, v60
    v_sub_f32 v61, v44, v60
    v_cvt_pk_bf16_f32 v16, v60, v61
    v_cndmask_b32 v45, 0, v45, vcc
    v_cvt_pk_bf16_f32 v60, v45, v45
    v_lshlrev_b32 v60, 16, v60
    v_sub_f32 v61, v45, v60
    v_cvt_pk_bf16_f32 v20, v60, v61
    v_cndmask_b32 v46, 0, v46, vcc
    v_cvt_pk_bf16_f32 v60, v46, v46
    v_lshlrev_b32 v60, 16, v60
    v_sub_f32 v61, v46, v60
    v_cvt_pk_bf16_f32 v24, v60, v61
    v_pk_add_f32 v[54:55], v[54:55], v[56:57]
    v_mul_f32 v54, 0x3b000000, v54
    v_cvt_pk_bf16_f32 v160, -v54, -v54
    v_mov_b32 v161, 0
    v_mov_b32 v162, 0
    v_mov_b32 v163, 0
    v_mul_f32 v55, 0x3b000000, v55
    v_fma_f32 v55, -v54, v54, v55
    v_mfma_f32_32x32x16_bf16 v[64:79], v[16:19], v[160:163], v[64:79]
    v_mfma_f32_32x32x16_bf16 v[80:95], v[20:23], v[160:163], v[80:95]
    v_mfma_f32_32x32x16_bf16 v[96:111], v[160:163], v[24:27], v[96:111]
    v_max_f32 v55, 0, v55
    v_cvt_pk_bf16_f32 v60, v55, v55
    v_lshlrev_b32 v60, 16, v60
    v_add_f32 v60, 0x3727c5ac, v60
    v_cvt_pk_bf16_f32 v60, v60, v60
    v_lshlrev_b32 v60, 16, v60
    v_sqrt_f32 v60, v60
    s_lshl_b32 s41, s26, 7
    v_cvt_pk_bf16_f32 v60, v60, v60
    v_lshlrev_b32 v60, 16, v60
    v_rcp_f32 v56, v60
    s_add_u32 s41, s41, 160768
    v_lshl_add_u32 v60, v12, 2, s41
    ds_write_b32 v60, v56
    v_mov_b32 v57, v56
    v_lshlrev_b32 v60, 5, v13
    v_add_u32 v60, s41, v60
    v_lshlrev_b32 v61, 9, v13
    v_lshl_add_u32 v61, v12, 4, v61
    v_mul_f32 v54, 0x3eb8aa3b, v56
    v_mul_f32 v55, 0x3eb8aa3b, v56
    ds_read_b128 v[28:31], v60
    ds_read_b128 v[32:35], v60 offset:16
    ds_read_b128 v[36:39], v60 offset:64
    ds_read_b128 v[40:43], v60 offset:80
    s_waitcnt lgkmcnt(5)
    v_pk_add_f32 v[64:65], v[64:65], v[112:113]
    v_pk_add_f32 v[66:67], v[66:67], v[114:115]
    v_pk_add_f32 v[68:69], v[68:69], v[116:117]
    v_pk_add_f32 v[70:71], v[70:71], v[118:119]
    v_pk_add_f32 v[72:73], v[72:73], v[120:121]
    v_pk_add_f32 v[74:75], v[74:75], v[122:123]
    v_pk_add_f32 v[76:77], v[76:77], v[124:125]
    v_pk_add_f32 v[78:79], v[78:79], v[126:127]
    v_pk_mul_f32 v[64:65], v[64:65], v[54:55]
    v_pk_mul_f32 v[66:67], v[66:67], v[54:55]
    v_pk_mul_f32 v[68:69], v[68:69], v[54:55]
    v_pk_mul_f32 v[70:71], v[70:71], v[54:55]
    v_pk_mul_f32 v[72:73], v[72:73], v[54:55]
    v_pk_mul_f32 v[74:75], v[74:75], v[54:55]
    v_pk_mul_f32 v[76:77], v[76:77], v[54:55]
    v_pk_mul_f32 v[78:79], v[78:79], v[54:55]
    v_cvt_pk_bf16_f32 v112, v64, v65
    v_cvt_pk_bf16_f32 v113, v66, v67
    v_cvt_pk_bf16_f32 v114, v68, v69
    v_cvt_pk_bf16_f32 v115, v70, v71
    v_cvt_pk_bf16_f32 v116, v72, v73
    v_cvt_pk_bf16_f32 v117, v74, v75
    v_cvt_pk_bf16_f32 v118, v76, v77
    v_cvt_pk_bf16_f32 v119, v78, v79
    buffer_store_dwordx4 v[112:115], v61, s[16:19], s30 offen sc1
    buffer_store_dwordx4 v[116:119], v61, s[16:19], s31 offen sc1
    s_waitcnt lgkmcnt(5)
    v_pk_add_f32 v[80:81], v[80:81], v[128:129]
    v_pk_add_f32 v[82:83], v[82:83], v[130:131]
    v_pk_add_f32 v[84:85], v[84:85], v[132:133]
    v_pk_add_f32 v[86:87], v[86:87], v[134:135]
    v_pk_add_f32 v[88:89], v[88:89], v[136:137]
    v_pk_add_f32 v[90:91], v[90:91], v[138:139]
    v_pk_add_f32 v[92:93], v[92:93], v[140:141]
    v_pk_add_f32 v[94:95], v[94:95], v[142:143]
    v_pk_mul_f32 v[80:81], v[80:81], v[56:57]
    v_pk_mul_f32 v[82:83], v[82:83], v[56:57]
    v_pk_mul_f32 v[84:85], v[84:85], v[56:57]
    v_pk_mul_f32 v[86:87], v[86:87], v[56:57]
    v_pk_mul_f32 v[88:89], v[88:89], v[56:57]
    v_pk_mul_f32 v[90:91], v[90:91], v[56:57]
    v_pk_mul_f32 v[92:93], v[92:93], v[56:57]
    v_pk_mul_f32 v[94:95], v[94:95], v[56:57]
    v_cvt_pk_bf16_f32 v128, v80, v81
    v_cvt_pk_bf16_f32 v129, v82, v83
    v_cvt_pk_bf16_f32 v130, v84, v85
    v_cvt_pk_bf16_f32 v131, v86, v87
    v_cvt_pk_bf16_f32 v132, v88, v89
    v_cvt_pk_bf16_f32 v133, v90, v91
    v_cvt_pk_bf16_f32 v134, v92, v93
    v_cvt_pk_bf16_f32 v135, v94, v95
    buffer_store_dwordx4 v[128:131], v61, s[16:19], s32 offen sc1
    buffer_store_dwordx4 v[132:135], v61, s[16:19], s33 offen sc1
    v_bfe_u32 v60, v1, 4, 1
    v_lshlrev_b32 v60, 17, v60
    v_lshl_add_u32 v60, v13, 8, v60
    v_and_b32 v62, 15, v1
    v_lshl_add_u32 v60, v62, 4, v60
    s_waitcnt lgkmcnt(0)
    v_pk_add_f32 v[96:97], v[96:97], v[144:145]
    v_pk_add_f32 v[98:99], v[98:99], v[146:147]
    v_pk_add_f32 v[100:101], v[100:101], v[148:149]
    v_pk_add_f32 v[102:103], v[102:103], v[150:151]
    v_pk_add_f32 v[104:105], v[104:105], v[152:153]
    v_pk_add_f32 v[106:107], v[106:107], v[154:155]
    v_pk_add_f32 v[108:109], v[108:109], v[156:157]
    v_pk_add_f32 v[110:111], v[110:111], v[158:159]
    v_pk_mul_f32 v[96:97], v[96:97], v[28:29]
    v_pk_mul_f32 v[98:99], v[98:99], v[30:31]
    v_pk_mul_f32 v[100:101], v[100:101], v[32:33]
    v_pk_mul_f32 v[102:103], v[102:103], v[34:35]
    v_pk_mul_f32 v[104:105], v[104:105], v[36:37]
    v_pk_mul_f32 v[106:107], v[106:107], v[38:39]
    v_pk_mul_f32 v[108:109], v[108:109], v[40:41]
    v_pk_mul_f32 v[110:111], v[110:111], v[42:43]
    v_cvt_pk_bf16_f32 v144, v96, v97
    v_cvt_pk_bf16_f32 v145, v98, v99
    v_cvt_pk_bf16_f32 v146, v100, v101
    v_cvt_pk_bf16_f32 v147, v102, v103
    v_cvt_pk_bf16_f32 v148, v104, v105
    v_cvt_pk_bf16_f32 v149, v106, v107
    v_cvt_pk_bf16_f32 v150, v108, v109
    v_cvt_pk_bf16_f32 v151, v110, v111
    buffer_store_dwordx4 v[144:147], v60, s[16:19], s32 offen offset:1024 sc1
    buffer_store_dwordx4 v[148:151], v60, s[16:19], s32 offen offset:1536 sc1
    v_mov_b32 v54, 0
    v_mov_b32 v55, 0
    v_dot2c_f32_bf16 v54, v128, v128
    v_dot2c_f32_bf16 v55, v132, v132
    v_dot2c_f32_bf16 v54, v129, v129
    v_dot2c_f32_bf16 v55, v133, v133
    v_dot2c_f32_bf16 v54, v130, v130
    v_dot2c_f32_bf16 v55, v134, v134
    v_dot2c_f32_bf16 v54, v131, v131
    v_dot2c_f32_bf16 v55, v135, v135
    s_lshl_b32 s30, s43, 8
    s_lshl_b32 s31, s42, 2
    s_add_u32 s30, s30, s31
    v_permlane32_swap_b32 v54, v55
    v_add_f32 v54, v54, v55
    s_nop 1
    v_max_f32_dpp v54, v54, v54 row_ror:8 row_mask:0xf bank_mask:0xf
    s_nop 1
    v_max_f32_dpp v54, v54, v54 row_ror:4 row_mask:0xf bank_mask:0xf
    s_nop 1
    v_max_f32_dpp v54, v54, v54 row_ror:2 row_mask:0xf bank_mask:0xf
    s_nop 1
    v_max_f32_dpp v54, v54, v54 row_ror:1 row_mask:0xf bank_mask:0xf
    v_mov_b32 v55, v54
    v_lshlrev_b32 v60, 8, v13
    s_add_u32 s30, s30, 0x2280000
    v_permlane16_swap_b32 v54, v55
    v_max_f32 v54, v54, v55
    s_mov_b32 s46, 1
    s_mov_b32 s47, 1
    s_mov_b64 exec, s[46:47]
    buffer_store_dword v54, v60, s[16:19], s30 offen sc1
    s_mov_b64 exec, 1
    v_mov_b32 v43, 1
    v_mov_b32 v42, 0
    s_lshl_b32 s30, s24, 12
    s_lshl_b32 s31, s23, 7
    s_add_u32 s30, s30, s31
    s_add_u32 s30, s30, 0xd11000
    s_waitcnt vmcnt(0)
    ds_add_rtn_u32 v44, v11, v43 offset:24
    s_waitcnt lgkmcnt(0)
    v_readfirstlane_b32 s44, v44
    s_nop 0
    s_cmp_lg_u32 s44, 3
    s_cbranch_scc1 H_end
    buffer_store_dword v43, v42, s[16:19], s30 offen sc0 sc1
H_end:
    s_mov_b64 exec, -1
F_next:
    s_mov_b32 s3, 1
    s_barrier
    s_branch A_again
F_out:
    buffer_store_dwordx4 v[80:83], v3, s[12:15], s36 offen
    buffer_store_dwordx4 v[84:87], v3, s[12:15], s36 offen offset:32
F_end:
A_done:
    s_endpgm
A_sync:
    v_mov_b32 v103, 163776
    ds_read_b128 v[104:107], v103
    s_waitcnt lgkmcnt(0)
    v_min3_u32 v104, v104, v105, v106
    v_min_u32 v104, v104, v107
    s_nop 0
    v_readfirstlane_b32 s37, v104
    s_branch A_loop
A_redo:
    s_mov_b32 s34, 1
    v_lshlrev_b32 v97, 4, v1
    v_mov_b32 v103, 0xff800000
    s_mov_b32 s35, 0
A_maxloop:
    ds_read_b128 v[72:75], v97
    s_waitcnt lgkmcnt(0)
    v_mfma_f32_32x32x16_bf16 v[24:39], v[72:75], v[4:7], 0
    v_add_u32 v97, 2048, v97
    s_nop 10
    v_max3_f32 v103, v24, v25, v103
    v_max3_f32 v103, v26, v27, v103
    v_max3_f32 v103, v28, v29, v103
    v_max3_f32 v103, v30, v31, v103
    v_max3_f32 v103, v32, v33, v103
    v_max3_f32 v103, v34, v35, v103
    v_max3_f32 v103, v36, v37, v103
    v_max3_f32 v103, v38, v39, v103
    s_add_u32 s35, s35, 1
    s_cmp_lt_u32 s35, 64
    s_cbranch_scc1 A_maxloop
    v_mov_b32 v104, v103
    s_nop 1
    v_permlane32_swap_b32 v103, v104
    v_max_f32 v103, v103, v104
    v_sub_f32 v8, 0, v103
    v_sub_f32 v9, 0, v103
    v_sub_f32 v10, 0, v103
    v_sub_f32 v11, 0, v103
    v_sub_f32 v12, 0, v103
    v_sub_f32 v13, 0, v103
    v_sub_f32 v14, 0, v103
    v_sub_f32 v15, 0, v103
    v_sub_f32 v16, 0, v103
    v_sub_f32 v17, 0, v103
    v_sub_f32 v18, 0, v103
    v_sub_f32 v19, 0, v103
    v_sub_f32 v20, 0, v103
    v_sub_f32 v21, 0, v103
    v_sub_f32 v22, 0, v103
    v_sub_f32 v23, 0, v103
    s_branch A_start
A_loader:
    s_setprio 3
    s_sub_u32 s22, s20, 8
    s_lshl_b32 s26, s22, 12
    s_lshl_b32 s25, s21, 17
    s_add_u32 s25, s25, s26
    s_add_u32 s25, s25, s49
    s_add_u32 s25, s25, 0x200000
    s_lshl_b32 s27, s22, 2
    s_add_u32 s27, s27, 163776
    v_mov_b32 v103, s27
    v_mov_b32 v104, 0
    ds_write_b32 v103, v104
    ds_write_b32 v103, v104 offset:16
    ds_write_b32 v103, v104 offset:32
    ds_write_b32 v103, v104 offset:48
    v_mov_b32 v108, 1
    s_mov_b32 s27, 0
    s_waitcnt lgkmcnt(0)
    s_mov_b32 s16, s28
    s_mov_b32 s17, s29
A_ld:
    s_mov_b32 m0, s26
    s_add_u32 s26, s26, 16384
    buffer_load_dwordx4 v97, s[16:19], s25 offen offset:0 lds
    buffer_load_dwordx4 v97, s[16:19], s25 offen offset:1024 lds
    buffer_load_dwordx4 v97, s[16:19], s25 offen offset:2048 lds
    buffer_load_dwordx4 v97, s[16:19], s25 offen offset:3072 lds
    s_add_u32 s25, s25, 16384
    s_add_u32 s27, s27, 1
    s_cmp_lt_u32 s27, 2
    s_cbranch_scc1 A_ld
    s_cmp_gt_u32 s27, 2
    s_cbranch_scc1 A_ld2
    s_waitcnt vmcnt(4)
    s_barrier
    s_branch A_ld
A_ld2:
    s_cmp_lt_u32 s27, 4
    s_cbranch_scc1 A_ld
    v_add_u32 v108, 1, v108
    s_waitcnt vmcnt(8)
    ds_write_b32 v103, v108
    s_cmp_lt_u32 s27, 8
    s_cbranch_scc1 A_ld
    v_mov_b32 v108, 8
    s_waitcnt vmcnt(0)
    ds_write_b32 v103, v108
    s_cmp_eq_u32 s3, 1
    s_cbranch_scc1 A_done
    s_load_dwordx4 s[40:43], s[0:1], 56
    s_sub_u32 s21, s20, 8
    s_and_b32 s22, s2, 7
    s_lshl_b32 s22, s22, 6
    s_lshr_b32 s23, s2, 3
    s_lshl_b32 s23, s23, 1
    s_add_u32 s22, s22, s23
    s_lshl_b32 s23, s21, 6
    v_add_u32 v2, s23, v1
    s_mul_i32 s30, s22, 5120
    s_lshl_b32 s31, s21, 10
    s_add_u32 s30, s30, s31
    s_add_u32 s30, s30, 0xe00000
    s_add_u32 s31, s31, 131072
    s_mov_b32 m0, s31
    s_add_u32 s32, s30, 5120
    buffer_load_dwordx4 v97, s[16:19], s30 offen lds
    s_add_u32 s33, s31, 7840
    s_mov_b32 m0, s33
    s_cmp_lg_u32 s21, 0
    buffer_load_dwordx4 v97, s[16:19], s32 offen lds
    s_cbranch_scc1 C_u1
    s_mov_b32 m0, 133120
    s_add_u32 s30, s30, 2048
    buffer_load_dwordx4 v97, s[16:19], s30 offen offset:2048 lds
    s_mov_b32 m0, 140960
    s_add_u32 s32, s32, 2048
    buffer_load_dwordx4 v97, s[16:19], s32 offen offset:2048 lds
C_u1:
    s_waitcnt lgkmcnt(0)
    s_mov_b32 s12, s40
    s_mov_b32 s13, s41
    s_mov_b32 s14, 0x200000
    s_mov_b32 s15, 0x20000
    s_lshl_b32 s30, s22, 1
    s_add_u32 s42, s42, s30
    s_addc_u32 s43, s43, 0
    s_load_dword s52, s[42:43], 0
    v_mov_b32 v6, 0x7ffff000
    v_cmp_eq_u32 vcc, 0, v2
    v_lshlrev_b32 v7, 4, v2
    v_subrev_u32 v8, 4, v7
    v_cndmask_b32 v8, v8, v6, vcc
    s_lshl_b32 s31, s22, 12
    s_add_u32 s32, s31, 4096
    buffer_load_dwordx4 v[36:39], v7, s[12:15], s31 offen
    buffer_load_dword v44, v8, s[12:15], s31 offen
    buffer_load_dwordx4 v[40:43], v7, s[12:15], s32 offen
    buffer_load_dword v45, v8, s[12:15], s32 offen
    v_mov_b32 v48, 0
    v_mov_b32 v49, 0
    v_mov_b32 v50, 0
    v_mov_b32 v51, 0
    v_add_u32 v9, 136192, v7
    v_cmp_gt_u32 vcc, 170, v2
    s_nop 0
    s_and_saveexec_b64 s[34:35], vcc
    ds_write_b128 v9, v[48:51]
    ds_write_b128 v9, v[48:51] offset:7840
    s_mov_b64 exec, s[34:35]
    v_and_b32 v9, 3, v2
    v_lshlrev_b32 v9, 4, v9
    v_lshrrev_b32 v10, 2, v2
    s_movk_i32 s33, 4160
    v_mul_lo_u32 v10, v10, s33
    v_add3_u32 v9, v9, v10, s33
    v_add_u32 v9, 142592, v9
    v_cmp_gt_u32 vcc, 8, v2
    s_nop 0
    s_and_saveexec_b64 s[34:35], vcc
    ds_write_b128 v9, v[48:51] offset:4288
    ds_write_b128 v9, v[48:51] offset:12800
    v_cmp_ne_u32 vcc, 4, v2
    s_nop 0
    s_and_b64 exec, exec, vcc
    ds_write_b128 v9, v[48:51] offset:0
    ds_write_b128 v9, v[48:51] offset:8512
    s_mov_b64 exec, s[34:35]
    s_waitcnt vmcnt(0)
    v_add_u32 v9, 146816, v7
    v_alignbit_b32 v52, v36, v44, 16
    v_alignbit_b32 v53, v37, v36, 16
    v_alignbit_b32 v54, v38, v37, 16
    v_alignbit_b32 v55, v39, v38, 16
    ds_write_b128 v9, v[52:55] offset:0
    ds_write_b128 v9, v[36:39] offset:4288
    v_alignbit_b32 v52, v40, v45, 16
    v_alignbit_b32 v53, v41, v40, 16
    v_alignbit_b32 v54, v42, v41, 16
    v_alignbit_b32 v55, v43, v42, 16
    ds_write_b128 v9, v[52:55] offset:8512
    ds_write_b128 v9, v[40:43] offset:12800
    v_cmp_eq_u32 vcc, 255, v2
    s_nop 0
    s_and_saveexec_b64 s[34:35], vcc
    v_lshrrev_b32 v48, 16, v39
    ds_write_b128 v9, v[48:51] offset:16
    v_lshrrev_b32 v48, 16, v43
    ds_write_b128 v9, v[48:51] offset:8528
    s_mov_b64 exec, s[34:35]
    v_mov_b32 v11, 163792
    v_mov_b32 v12, 1
    s_waitcnt lgkmcnt(0)
    s_mov_b64 exec, 1
    ds_add_u32 v11, v12
    s_mov_b64 exec, -1
    s_bitcmp1_b32 s21, 0
    s_cbranch_scc1 C_nw
    s_load_dwordx4 s[4:7], s[0:1], 8
    v_mov_b32 v72, -1
    v_mov_b32 v73, -1
    v_mov_b32 v74, -1
    v_mov_b32 v75, -1
    s_lshl_b32 s30, s2, 13
    s_lshl_b32 s31, s21, 11
    s_add_u32 s30, s30, s31
    s_add_u32 s30, s30, 0x1400000
    buffer_store_dwordx4 v[72:75], v97, s[16:19], s30 offen offset:0 sc1
    buffer_store_dwordx4 v[72:75], v97, s[16:19], s30 offen offset:1024 sc1
    buffer_store_dwordx4 v[72:75], v97, s[16:19], s30 offen offset:2048 sc1
    buffer_store_dwordx4 v[72:75], v97, s[16:19], s30 offen offset:3072 sc1
    s_mov_b32 s53, s21
    s_mov_b32 s54, s22
    s_lshr_b32 s21, s21, 1
    s_lshl_b32 s22, s2, 1
    s_add_u32 s21, s21, s22
    s_mov_b32 s11, 0x20000
    s_waitcnt lgkmcnt(0)
    v_lshrrev_b32 v90, 5, v1
    v_and_b32 v89, 31, v1
    v_and_b32 v91, 4, v89
    v_and_b32 v92, 1, v89
    v_lshl_or_b32 v91, v92, 1, v91
    v_bfe_u32 v92, v89, 1, 1
    v_or_b32 v91, v91, v92
    v_lshlrev_b32 v91, 6, v91
    v_lshl_add_u32 v91, v90, 9, v91
    v_lshrrev_b32 v92, 3, v89
    s_cmp_ge_u32 s21, 384
    s_cbranch_scc1 R_wo
    s_mul_hi_u32 s22, s21, 0x15555556
    s_mul_i32 s23, s22, 12
    s_sub_u32 s23, s21, s23
    s_movk_i32 s24, 3072
    s_mov_b32 s10, 0x180000
    s_mov_b32 s25, 98304
    s_and_b32 s26, s23, 3
    s_mul_i32 s26, s26, 393216
    s_mul_i32 s27, s22, 3072
    s_add_u32 s26, s26, s27
    s_lshr_b32 s27, s23, 2
    s_lshl_b32 s27, s27, 10
    s_add_u32 s26, s26, s27
    s_add_u32 s26, s26, 0x1080000
    s_mov_b32 s8, s4
    s_mov_b32 s9, s5
    s_branch R_w2
R_wo:
    s_sub_u32 s21, s21, 384
    s_lshr_b32 s22, s21, 2
    s_and_b32 s23, s21, 3
    s_movk_i32 s24, 1024
    s_mov_b32 s10, 0x80000
    s_mov_b32 s25, 32768
    s_lshl_b32 s26, s23, 17
    s_lshl_b32 s27, s22, 10
    s_add_u32 s26, s26, s27
    s_add_u32 s26, s26, 0xc00000
    s_mov_b32 s8, s6
    s_mov_b32 s9, s7
R_w2:
    s_lshl_b32 s27, s24, 3
    v_mul_lo_u32 v88, v90, s27
    v_lshl_add_u32 v88, v89, 3, v88
    s_mul_i32 s30, s22, s27
    s_lshl_b32 s30, s30, 1
    s_lshl_b32 s31, s23, 8
    s_add_u32 s30, s30, s31
    buffer_load_dwordx2 v[56:57], v88, s[8:11], s30 offen
    s_add_u32 s30, s30, s24
    buffer_load_dwordx2 v[58:59], v88, s[8:11], s30 offen
    s_add_u32 s30, s30, s24
    buffer_load_dwordx2 v[60:61], v88, s[8:11], s30 offen
    s_add_u32 s30, s30, s24
    buffer_load_dwordx2 v[62:63], v88, s[8:11], s30 offen
    s_add_u32 s30, s30, s24
    buffer_load_dwordx2 v[64:65], v88, s[8:11], s30 offen
    s_add_u32 s30, s30, s24
    buffer_load_dwordx2 v[66:67], v88, s[8:11], s30 offen
    s_add_u32 s30, s30, s24
    buffer_load_dwordx2 v[68:69], v88, s[8:11], s30 offen
    s_add_u32 s30, s30, s24
    buffer_load_dwordx2 v[70:71], v88, s[8:11], s30 offen
    v_mul_lo_u32 v92, v92, s25
    v_add_u32 v91, v91, v92
    s_mov_b32 s34, 0x05040100
    s_mov_b32 s35, 0x07060302
    s_waitcnt vmcnt(0)
    v_perm_b32 v72, v58, v56, s34
    v_perm_b32 v73, v62, v60, s34
    v_perm_b32 v74, v66, v64, s34
    v_perm_b32 v75, v70, v68, s34
    buffer_store_dwordx4 v[72:75], v91, s[16:19], s26 offen offset:0 sc1
    v_perm_b32 v76, v58, v56, s35
    v_perm_b32 v77, v62, v60, s35
    v_perm_b32 v78, v66, v64, s35
    v_perm_b32 v79, v70, v68, s35
    buffer_store_dwordx4 v[76:79], v91, s[16:19], s26 offen offset:16 sc1
    v_perm_b32 v80, v59, v57, s34
    v_perm_b32 v81, v63, v61, s34
    v_perm_b32 v82, v67, v65, s34
    v_perm_b32 v83, v71, v69, s34
    buffer_store_dwordx4 v[80:83], v91, s[16:19], s26 offen offset:32 sc1
    v_perm_b32 v84, v59, v57, s35
    v_perm_b32 v85, v63, v61, s35
    v_perm_b32 v86, v67, v65, s35
    v_perm_b32 v87, v71, v69, s35
    buffer_store_dwordx4 v[84:87], v91, s[16:19], s26 offen offset:48 sc1
    s_mov_b32 s21, s53
    s_mov_b32 s22, s54
    v_mov_b32 v13, 0
    s_and_b32 s44, s2, 7
    s_lshl_b32 s44, s44, 12
    s_lshr_b32 s45, s2, 3
    s_lshl_b32 s45, s45, 7
    s_add_u32 s44, s44, s45
    s_add_u32 s44, s44, 0xd21000
    s_waitcnt vmcnt(0)
    s_mov_b64 exec, 1
    ds_add_rtn_u32 v14, v11, v12 offset:12
    s_waitcnt lgkmcnt(0)
    v_readfirstlane_b32 s48, v14
    s_nop 0
    s_cmp_lg_u32 s48, 1
    s_cbranch_scc1 C_nf
    buffer_store_dword v12, v13, s[16:19], s44 offen sc0 sc1
C_nf:
    s_mov_b64 exec, -1
C_nw:
    s_lshr_b32 s33, s21, 1
    s_and_b32 s34, s21, 1
    v_and_b32 v3, 31, v1
    v_lshrrev_b32 v4, 5, v1
    v_add_u32 v5, 2, v3
    v_lshrrev_b32 v5, 1, v5
    v_lshl_add_u32 v5, v4, 2, v5
    v_lshlrev_b32 v5, 2, v5
    v_and_b32 v6, 1, v3
    v_mul_u32_u24 v6, 4288, v6
    s_mul_i32 s35, s33, 8512
    s_add_u32 s35, s35, 146752
    v_add3_u32 v5, v5, v6, s35
    s_lshl_b32 s35, s34, 5
    s_sub_u32 s35, 63, s35
    v_sub_u32 v8, s35, v3
    v_mul_u32_u24 v8, 80, v8
    s_mul_i32 s35, s33, 7840
    s_add_u32 s35, s35, 131072
    v_add_u32 v8, s35, v8
    v_lshl_add_u32 v6, v4, 4, v8
    v_lshlrev_b32 v9, 3, v4
    v_sub_u32 v7, v8, v9
    s_mul_i32 s35, s34, 6
    s_add_u32 s35, s35, 7
C_spin:
    ds_read_b32 v12, v11
    s_waitcnt lgkmcnt(0)
    v_readfirstlane_b32 s36, v12
    s_nop 0
    s_cmp_ge_u32 s36, 4
    s_cbranch_scc1 C_go
    s_sleep 2
    s_branch C_spin
C_go:
    v_mov_b32 v16, 0
    v_mov_b32 v17, 0
    v_mov_b32 v18, 0
    v_mov_b32 v19, 0
    v_mov_b32 v20, 0
    v_mov_b32 v21, 0
    v_mov_b32 v22, 0
    v_mov_b32 v23, 0
    v_mov_b32 v24, 0
    v_mov_b32 v25, 0
    v_mov_b32 v26, 0
    v_mov_b32 v27, 0
    v_mov_b32 v28, 0
    v_mov_b32 v29, 0
    v_mov_b32 v30, 0
    v_mov_b32 v31, 0
C_loop:
    ds_read2_b32 v[32:33], v5 offset0:0 offset1:1
    ds_read2_b32 v[34:35], v5 offset0:2 offset1:3
    ds_read_b128 v[36:39], v6 offset:0
    s_waitcnt lgkmcnt(0)
    v_mfma_f32_32x32x16_bf16 v[16:31], v[32:35], v[36:39], v[16:31]
    ds_read2_b32 v[40:41], v5 offset0:8 offset1:9
    ds_read2_b32 v[42:43], v5 offset0:10 offset1:11
    ds_read_b128 v[44:47], v6 offset:32
    s_waitcnt lgkmcnt(0)
    v_mfma_f32_32x32x16_bf16 v[16:31], v[40:43], v[44:47], v[16:31]
    ds_read2_b32 v[48:49], v5 offset0:16 offset1:17
    ds_read2_b32 v[50:51], v5 offset0:18 offset1:19
    ds_read_b128 v[52:55], v6 offset:80
    s_waitcnt lgkmcnt(0)
    v_mfma_f32_32x32x16_bf16 v[16:31], v[48:51], v[52:55], v[16:31]
    ds_read2_b32 v[56:57], v5 offset0:24 offset1:25
    ds_read2_b32 v[58:59], v5 offset0:26 offset1:27
    ds_read_b128 v[60:63], v6 offset:112
    s_waitcnt lgkmcnt(0)
    v_mfma_f32_32x32x16_bf16 v[16:31], v[56:59], v[60:63], v[16:31]
    ds_read2_b32 v[64:65], v5 offset0:32 offset1:33
    ds_read2_b32 v[66:67], v5 offset0:34 offset1:35
    ds_read_b128 v[68:71], v6 offset:160
    s_waitcnt lgkmcnt(0)
    v_mfma_f32_32x32x16_bf16 v[16:31], v[64:67], v[68:71], v[16:31]
    ds_read2_b32 v[32:33], v5 offset0:40 offset1:41
    ds_read2_b32 v[34:35], v5 offset0:42 offset1:43
    ds_read_b128 v[36:39], v6 offset:192
    s_waitcnt lgkmcnt(0)
    v_mfma_f32_32x32x16_bf16 v[16:31], v[32:35], v[36:39], v[16:31]
    ds_read2_b32 v[40:41], v5 offset0:48 offset1:49
    ds_read2_b32 v[42:43], v5 offset0:50 offset1:51
    ds_read_b128 v[44:47], v6 offset:240
    s_waitcnt lgkmcnt(0)
    v_mfma_f32_32x32x16_bf16 v[16:31], v[40:43], v[44:47], v[16:31]
    ds_read2_b32 v[48:49], v5 offset0:56 offset1:57
    ds_read2_b32 v[50:51], v5 offset0:58 offset1:59
    ds_read_b128 v[52:55], v6 offset:272
    s_waitcnt lgkmcnt(0)
    v_mfma_f32_32x32x16_bf16 v[16:31], v[48:51], v[52:55], v[16:31]
    ds_read2_b32 v[56:57], v5 offset0:64 offset1:65
    ds_read2_b32 v[58:59], v5 offset0:66 offset1:67
    ds_read_b128 v[60:63], v6 offset:320
    s_waitcnt lgkmcnt(0)
    v_mfma_f32_32x32x16_bf16 v[16:31], v[56:59], v[60:63], v[16:31]
    ds_read2_b32 v[64:65], v5 offset0:72 offset1:73
    ds_read2_b32 v[66:67], v5 offset0:74 offset1:75
    ds_read_b128 v[68:71], v6 offset:352
    s_waitcnt lgkmcnt(0)
    v_mfma_f32_32x32x16_bf16 v[16:31], v[64:67], v[68:71], v[16:31]
    v_add_u32 v5, 320, v5
    v_add_u32 v6, 400, v6
    s_sub_u32 s35, s35, 1
    s_cmp_lg_u32 s35, 0
    s_cbranch_scc1 C_loop
    s_waitcnt lgkmcnt(0)
    ds_read_b64 v[72:73], v7 offset:56
    ds_read_b64 v[74:75], v7 offset:40
    ds_read_b64 v[76:77], v7 offset:24
    ds_read_b64 v[78:79], v7 offset:8
    s_lshl_b32 s36, s33, 4
    s_lshr_b32 s36, s52, s36
    s_lshl_b32 s36, s36, 16
    s_add_u32 s37, s22, s33
    s_lshl_b32 s38, s37, 6
    s_lshl_b32 s39, s34, 20
    s_add_u32 s38, s38, s39
    s_add_u32 s38, s38, 0x800000
    v_lshlrev_b32 v8, 15, v3
    v_lshl_add_u32 v8, v4, 3, v8
    s_waitcnt lgkmcnt(0)
    v_and_b32 v80, 0xffff0000, v73
    v_lshlrev_b32 v81, 16, v73
    v_and_b32 v82, 0xffff0000, v72
    v_lshlrev_b32 v83, 16, v72
    v_mul_f32 v80, s36, v80
    v_mul_f32 v81, s36, v81
    v_mul_f32 v82, s36, v82
    v_mul_f32 v83, s36, v83
    v_cvt_pk_bf16_f32 v84, v80, v81
    v_cvt_pk_bf16_f32 v85, v16, v17
    v_lshlrev_b32 v80, 16, v84
    v_and_b32 v81, 0xffff0000, v84
    v_lshlrev_b32 v86, 16, v85
    v_and_b32 v87, 0xffff0000, v85
    v_add_f32 v80, v80, v86
    v_add_f32 v81, v81, v87
    v_cvt_pk_bf16_f32 v88, v80, v81
    v_cvt_pk_bf16_f32 v84, v82, v83
    v_cvt_pk_bf16_f32 v85, v18, v19
    v_lshlrev_b32 v82, 16, v84
    v_and_b32 v83, 0xffff0000, v84
    v_lshlrev_b32 v86, 16, v85
    v_and_b32 v87, 0xffff0000, v85
    v_add_f32 v82, v82, v86
    v_add_f32 v83, v83, v87
    v_cvt_pk_bf16_f32 v89, v82, v83
    buffer_store_dwordx2 v[88:89], v8, s[16:19], s38 offen offset:0 sc1
    v_and_b32 v80, 0xffff0000, v75
    v_lshlrev_b32 v81, 16, v75
    v_and_b32 v82, 0xffff0000, v74
    v_lshlrev_b32 v83, 16, v74
    v_mul_f32 v80, s36, v80
    v_mul_f32 v81, s36, v81
    v_mul_f32 v82, s36, v82
    v_mul_f32 v83, s36, v83
    v_cvt_pk_bf16_f32 v84, v80, v81
    v_cvt_pk_bf16_f32 v85, v20, v21
    v_lshlrev_b32 v80, 16, v84
    v_and_b32 v81, 0xffff0000, v84
    v_lshlrev_b32 v86, 16, v85
    v_and_b32 v87, 0xffff0000, v85
    v_add_f32 v80, v80, v86
    v_add_f32 v81, v81, v87
    v_cvt_pk_bf16_f32 v90, v80, v81
    v_cvt_pk_bf16_f32 v84, v82, v83
    v_cvt_pk_bf16_f32 v85, v22, v23
    v_lshlrev_b32 v82, 16, v84
    v_and_b32 v83, 0xffff0000, v84
    v_lshlrev_b32 v86, 16, v85
    v_and_b32 v87, 0xffff0000, v85
    v_add_f32 v82, v82, v86
    v_add_f32 v83, v83, v87
    v_cvt_pk_bf16_f32 v91, v82, v83
    buffer_store_dwordx2 v[90:91], v8, s[16:19], s38 offen offset:16 sc1
    v_and_b32 v80, 0xffff0000, v77
    v_lshlrev_b32 v81, 16, v77
    v_and_b32 v82, 0xffff0000, v76
    v_lshlrev_b32 v83, 16, v76
    v_mul_f32 v80, s36, v80
    v_mul_f32 v81, s36, v81
    v_mul_f32 v82, s36, v82
    v_mul_f32 v83, s36, v83
    v_cvt_pk_bf16_f32 v84, v80, v81
    v_cvt_pk_bf16_f32 v85, v24, v25
    v_lshlrev_b32 v80, 16, v84
    v_and_b32 v81, 0xffff0000, v84
    v_lshlrev_b32 v86, 16, v85
    v_and_b32 v87, 0xffff0000, v85
    v_add_f32 v80, v80, v86
    v_add_f32 v81, v81, v87
    v_cvt_pk_bf16_f32 v92, v80, v81
    v_cvt_pk_bf16_f32 v84, v82, v83
    v_cvt_pk_bf16_f32 v85, v26, v27
    v_lshlrev_b32 v82, 16, v84
    v_and_b32 v83, 0xffff0000, v84
    v_lshlrev_b32 v86, 16, v85
    v_and_b32 v87, 0xffff0000, v85
    v_add_f32 v82, v82, v86
    v_add_f32 v83, v83, v87
    v_cvt_pk_bf16_f32 v93, v82, v83
    buffer_store_dwordx2 v[92:93], v8, s[16:19], s38 offen offset:32 sc1
    v_and_b32 v80, 0xffff0000, v79
    v_lshlrev_b32 v81, 16, v79
    v_and_b32 v82, 0xffff0000, v78
    v_lshlrev_b32 v83, 16, v78
    v_mul_f32 v80, s36, v80
    v_mul_f32 v81, s36, v81
    v_mul_f32 v82, s36, v82
    v_mul_f32 v83, s36, v83
    v_cvt_pk_bf16_f32 v84, v80, v81
    v_cvt_pk_bf16_f32 v85, v28, v29
    v_lshlrev_b32 v80, 16, v84
    v_and_b32 v81, 0xffff0000, v84
    v_lshlrev_b32 v86, 16, v85
    v_and_b32 v87, 0xffff0000, v85
    v_add_f32 v80, v80, v86
    v_add_f32 v81, v81, v87
    v_cvt_pk_bf16_f32 v94, v80, v81
    v_cvt_pk_bf16_f32 v84, v82, v83
    v_cvt_pk_bf16_f32 v85, v30, v31
    v_lshlrev_b32 v82, 16, v84
    v_and_b32 v83, 0xffff0000, v84
    v_lshlrev_b32 v86, 16, v85
    v_and_b32 v87, 0xffff0000, v85
    v_add_f32 v82, v82, v86
    v_add_f32 v83, v83, v87
    v_cvt_pk_bf16_f32 v95, v82, v83
    buffer_store_dwordx2 v[94:95], v8, s[16:19], s38 offen offset:48 sc1
    v_mov_b32 v11, 163796
    v_mov_b32 v10, 1
    s_cmp_lg_u32 s20, 8
    s_cbranch_scc1 C_s2
    s_mov_b32 s39, 0x40000
    v_lshlrev_b32 v13, 7, v1
    s_mov_b32 s44, 0xd21000
    s_mov_b32 s45, 0xd23000
    s_mov_b32 s46, 0xd25000
    s_mov_b32 s47, 0xd27000
C_p1:
    buffer_load_dword v14, v13, s[16:19], s44 offen sc0 sc1
    buffer_load_dword v15, v13, s[16:19], s45 offen sc0 sc1
    buffer_load_dword v16, v13, s[16:19], s46 offen sc0 sc1
    buffer_load_dword v17, v13, s[16:19], s47 offen sc0 sc1
    s_waitcnt vmcnt(0)
    v_max3_u32 v14, v14, v15, v16
    v_max_u32 v14, v14, v17
    v_cmp_eq_u32 vcc, -1, v14
    s_sub_u32 s39, s39, 1
    s_cbranch_scc1 C_p1_ok
    s_cbranch_vccz C_p1_ok
    s_sleep 32
    s_branch C_p1
C_p1_ok:
    ds_write_b32 v11, v10 offset:4
C_s2:
    s_waitcnt vmcnt(0)
    s_mov_b64 exec, 1
    ds_add_rtn_u32 v12, v11, v10
    s_mov_b64 exec, -1
    s_and_b32 s44, s2, 7
    s_lshl_b32 s44, s44, 12
    s_lshr_b32 s45, s2, 3
    s_lshl_b32 s45, s45, 7
    s_add_u32 s44, s44, s45
    s_add_u32 s44, s44, 0xd21000
    v_mov_b32 v13, 0
    v_mov_b32 v10, 2
    s_waitcnt lgkmcnt(0)
    v_readfirstlane_b32 s48, v12
    s_nop 0
    s_cmp_lg_u32 s48, 3
    s_cbranch_scc1 C_fin
    s_mov_b64 exec, 1
    buffer_store_dword v10, v13, s[16:19], s44 offen sc0 sc1
    s_mov_b64 exec, -1
    s_mov_b32 s39, 0x40000
    v_lshlrev_b32 v13, 7, v1
    s_lshr_b32 s44, s2, 6
    s_lshl_b32 s44, s44, 13
    s_add_u32 s44, s44, 0xd21000
C_p2:
    buffer_load_dword v14, v13, s[16:19], s44 offen sc0 sc1
    s_waitcnt vmcnt(0)
    v_cmp_ne_u32 vcc, 2, v14
    s_sub_u32 s39, s39, 1
    s_cbranch_scc1 C_p2_ok
    s_cbranch_vccz C_p2_ok
    s_sleep 8
    s_branch C_p2
C_p2_ok:
C_fin:
    s_barrier
    v_mov_b32 v104, 0
    ds_write_b32 v103, v104
    s_waitcnt lgkmcnt(0)
    s_barrier
    s_sub_u32 s26, s20, 8
    s_lshr_b32 s21, s26, 1
    s_and_b32 s22, s26, 1
    s_and_b32 s30, s2, 7
    s_lshr_b32 s31, s2, 3
    s_and_b32 s23, s30, 3
    s_lshl_b32 s23, s23, 3
    s_and_b32 s32, s31, 7
    s_add_u32 s23, s23, s32
    s_lshr_b32 s24, s30, 2
    s_lshl_b32 s24, s24, 2
    s_lshr_b32 s31, s31, 3
    s_add_u32 s24, s24, s31
    s_lshl_b32 s33, s23, 16
    s_lshl_b32 s34, s26, 14
    s_add_u32 s33, s33, s34
    s_add_u32 s33, s33, 0xa00000
    v_lshlrev_b32 v12, 4, v1
    s_lshl_b32 s37, s26, 14
    s_add_u32 s37, s37, 45056
    v_add_u32 v14, s37, v12
    v_mov_b32 v20, 163808
    v_mov_b32 v21, 1
    s_cmp_eq_u32 s26, 0
    s_cbranch_scc1 G_w8
    v_lshlrev_b32 v13, 7, v1
    s_mul_i32 s34, s24, 196608
    s_mul_i32 s35, s32, 24576
    s_add_u32 s34, s34, s35
    s_lshl_b32 s35, s26, 13
    s_add_u32 s34, s34, s35
    s_add_u32 s34, s34, 0x107e000
    buffer_load_dword v15, v13, s[16:19], s34 offen
    s_branch G_go
G_w8:
    s_mov_b32 s39, 0x40000
    v_and_b32 v13, 7, v1
    v_lshlrev_b32 v13, 7, v13
    s_lshl_b32 s34, s23, 10
    s_add_u32 s34, s34, 0xd19000
    s_branch G_pd_1
G_pd:
    s_sleep 2
G_pd_1:
    ds_read_b32 v22, v20 offset:4
    s_waitcnt lgkmcnt(0)
    v_readfirstlane_b32 s44, v22
    s_nop 0
    s_cmp_lt_u32 s44, 1
    s_cbranch_scc1 G_pd
G_poll:
    buffer_load_dword v15, v13, s[16:19], s34 offen sc0 sc1
    s_waitcnt vmcnt(0)
    v_cmp_ne_u32 vcc, 1, v15
    s_sub_u32 s39, s39, 1
    s_cbranch_scc1 G_got
    s_cbranch_vccnz G_poll
G_got:
    ds_write_b32 v20, v21 offset:28
G_go:
    s_branch G_gw_1
G_gw:
    s_sleep 1
G_gw_1:
    ds_read_b32 v22, v20 offset:28
    s_waitcnt lgkmcnt(0)
    v_readfirstlane_b32 s44, v22
    s_nop 0
    s_cmp_lt_u32 s44, 1
    s_cbranch_scc1 G_gw
    s_mov_b32 s35, 4
G_dl:
    s_mov_b32 m0, s37
    s_add_u32 s37, s37, 4096
    buffer_load_dwordx4 v12, s[16:19], s33 offen offset:0 lds
    buffer_load_dwordx4 v12, s[16:19], s33 offen offset:1024 lds
    buffer_load_dwordx4 v12, s[16:19], s33 offen offset:2048 lds
    buffer_load_dwordx4 v12, s[16:19], s33 offen offset:3072 lds
    s_add_u32 s33, s33, 4096
    s_sub_u32 s35, s35, 1
    s_cmp_lg_u32 s35, 0
    s_cbranch_scc1 G_dl
    s_lshl_b32 s35, s22, 3
    s_lshl_b32 s36, s21, 2
    s_add_u32 s35, s35, s36
    s_add_u32 s35, s35, 163776
    v_mov_b32 v22, s35
    v_mov_b32 v23, 1
    s_waitcnt vmcnt(12)
    ds_write_b32 v22, v23
    v_mov_b32 v23, 2
    s_waitcnt vmcnt(8)
    ds_write_b32 v22, v23
    v_mov_b32 v23, 3
    s_waitcnt vmcnt(4)
    ds_write_b32 v22, v23
    v_mov_b32 v23, 4
    s_waitcnt vmcnt(0)
    ds_write_b32 v22, v23
    v_and_b32 v11, 31, v1
    v_mov_b32 v16, v14
    v_mov_b32 v12, 0
    v_mov_b32 v13, 0
    v_mov_b32 v14, 0
    v_mov_b32 v15, 0
    s_mov_b32 s45, 0xffff0000
    s_mov_b32 s42, 0
G_sl:
    ds_read_b128 v[24:27], v16 offset:0
    ds_read_b128 v[28:31], v16 offset:1024
    ds_read_b128 v[32:35], v16 offset:2048
    ds_read_b128 v[36:39], v16 offset:3072
    v_add_u32 v16, 0x1000, v16
    s_waitcnt lgkmcnt(0)
    v_lshlrev_b32 v40, 16, v24
    v_and_b32 v41, s45, v24
    v_add_f32 v12, v12, v40
    v_add_f32 v13, v13, v41
    v_fmac_f32 v14, v40, v40
    v_fmac_f32 v15, v41, v41
    v_lshlrev_b32 v42, 16, v25
    v_and_b32 v43, s45, v25
    v_add_f32 v12, v12, v42
    v_add_f32 v13, v13, v43
    v_fmac_f32 v14, v42, v42
    v_fmac_f32 v15, v43, v43
    v_lshlrev_b32 v40, 16, v26
    v_and_b32 v41, s45, v26
    v_add_f32 v12, v12, v40
    v_add_f32 v13, v13, v41
    v_fmac_f32 v14, v40, v40
    v_fmac_f32 v15, v41, v41
    v_lshlrev_b32 v42, 16, v27
    v_and_b32 v43, s45, v27
    v_add_f32 v12, v12, v42
    v_add_f32 v13, v13, v43
    v_fmac_f32 v14, v42, v42
    v_fmac_f32 v15, v43, v43
    v_lshlrev_b32 v40, 16, v28
    v_and_b32 v41, s45, v28
    v_add_f32 v12, v12, v40
    v_add_f32 v13, v13, v41
    v_fmac_f32 v14, v40, v40
    v_fmac_f32 v15, v41, v41
    v_lshlrev_b32 v42, 16, v29
    v_and_b32 v43, s45, v29
    v_add_f32 v12, v12, v42
    v_add_f32 v13, v13, v43
    v_fmac_f32 v14, v42, v42
    v_fmac_f32 v15, v43, v43
    v_lshlrev_b32 v40, 16, v30
    v_and_b32 v41, s45, v30
    v_add_f32 v12, v12, v40
    v_add_f32 v13, v13, v41
    v_fmac_f32 v14, v40, v40
    v_fmac_f32 v15, v41, v41
    v_lshlrev_b32 v42, 16, v31
    v_and_b32 v43, s45, v31
    v_add_f32 v12, v12, v42
    v_add_f32 v13, v13, v43
    v_fmac_f32 v14, v42, v42
    v_fmac_f32 v15, v43, v43
    v_lshlrev_b32 v40, 16, v32
    v_and_b32 v41, s45, v32
    v_add_f32 v12, v12, v40
    v_add_f32 v13, v13, v41
    v_fmac_f32 v14, v40, v40
    v_fmac_f32 v15, v41, v41
    v_lshlrev_b32 v42, 16, v33
    v_and_b32 v43, s45, v33
    v_add_f32 v12, v12, v42
    v_add_f32 v13, v13, v43
    v_fmac_f32 v14, v42, v42
    v_fmac_f32 v15, v43, v43
    v_lshlrev_b32 v40, 16, v34
    v_and_b32 v41, s45, v34
    v_add_f32 v12, v12, v40
    v_add_f32 v13, v13, v41
    v_fmac_f32 v14, v40, v40
    v_fmac_f32 v15, v41, v41
    v_lshlrev_b32 v42, 16, v35
    v_and_b32 v43, s45, v35
    v_add_f32 v12, v12, v42
    v_add_f32 v13, v13, v43
    v_fmac_f32 v14, v42, v42
    v_fmac_f32 v15, v43, v43
    v_lshlrev_b32 v40, 16, v36
    v_and_b32 v41, s45, v36
    v_add_f32 v12, v12, v40
    v_add_f32 v13, v13, v41
    v_fmac_f32 v14, v40, v40
    v_fmac_f32 v15, v41, v41
    v_lshlrev_b32 v42, 16, v37
    v_and_b32 v43, s45, v37
    v_add_f32 v12, v12, v42
    v_add_f32 v13, v13, v43
    v_fmac_f32 v14, v42, v42
    v_fmac_f32 v15, v43, v43
    v_lshlrev_b32 v40, 16, v38
    v_and_b32 v41, s45, v38
    v_add_f32 v12, v12, v40
    v_add_f32 v13, v13, v41
    v_fmac_f32 v14, v40, v40
    v_fmac_f32 v15, v41, v41
    v_lshlrev_b32 v42, 16, v39
    v_and_b32 v43, s45, v39
    v_add_f32 v12, v12, v42
    v_add_f32 v13, v13, v43
    v_fmac_f32 v14, v42, v42
    v_fmac_f32 v15, v43, v43
    s_add_u32 s42, s42, 1
    s_cmp_lt_u32 s42, 4
    s_cbranch_scc1 G_sl
    v_add_f32 v12, v12, v13
    v_add_f32 v13, v14, v15
    v_mov_b32 v14, v12
    v_mov_b32 v15, v13
    s_lshl_b32 s42, s22, 1
    s_add_u32 s42, s42, s21
    s_lshl_b32 s42, s42, 8
    s_add_u32 s42, s42, 159744
    v_permlane32_swap_b32 v12, v14
    v_permlane32_swap_b32 v13, v15
    v_pk_add_f32 v[12:13], v[12:13], v[14:15]
    v_lshl_add_u32 v22, v11, 3, s42
    ds_write_b64 v22, v[12:13]
    s_mov_b64 exec, 1
    ds_add_u32 v20, v21 offset:12
    s_mov_b64 exec, -1
    s_cmp_lg_u32 s20, 8
    s_cbranch_scc1 G_end
    s_and_b32 s44, s2, 7
    s_lshl_b32 s44, s44, 12
    s_add_u32 s33, s44, 0xd11000
    v_lshlrev_b32 v12, 7, v11
    s_branch G_kd_1
G_kd:
    s_sleep 2
G_kd_1:
    ds_read_b32 v22, v20 offset:24
    s_waitcnt lgkmcnt(0)
    v_readfirstlane_b32 s44, v22
    s_nop 0
    s_cmp_lt_u32 s44, 4
    s_cbranch_scc1 G_kd
    s_mov_b32 s39, 0x40000
G_fp:
    buffer_load_dword v13, v12, s[16:19], s33 offen sc0 sc1
    s_waitcnt vmcnt(0)
    v_cmp_ne_u32 vcc, 1, v13
    s_sub_u32 s39, s39, 1
    s_cbranch_scc1 G_end
    s_cbranch_vccz G_end
    s_sleep 2
    s_branch G_fp
G_end:
    s_branch F_next
.section .rodata,"a"
.p2align 6
.amdhsa_kernel k1_kernel
  .amdhsa_next_free_vgpr 128
  .amdhsa_next_free_sgpr 96
  .amdhsa_accum_offset 128
  .amdhsa_group_segment_fixed_size 0
  .amdhsa_kernarg_size 96
  .amdhsa_user_sgpr_count 2
  .amdhsa_user_sgpr_kernarg_segment_ptr 1
  .amdhsa_system_sgpr_workgroup_id_x 1
.end_amdhsa_kernel
.p2align 6
.amdhsa_kernel a1_kernel
  .amdhsa_next_free_vgpr 168
  .amdhsa_next_free_sgpr 96
  .amdhsa_accum_offset 168
  .amdhsa_group_segment_fixed_size 0
  .amdhsa_kernarg_size 96
  .amdhsa_user_sgpr_count 2
  .amdhsa_user_sgpr_kernarg_segment_ptr 1
  .amdhsa_system_sgpr_workgroup_id_x 1
.end_amdhsa_kernel
```
